```python
import torch

def _softmax(x, axis=-1):
    return torch.softmax(x, dim=axis)
def _gelu(x):
    return torch.nn.functional.gelu(x, approximate="tanh")
def _silu(x):
    return torch.nn.functional.silu(x)
def _sigmoid(x):
    return torch.sigmoid(x)
def _layernorm(x, axis=-1, eps=1e-5):
    m = x.mean(dim=axis, keepdim=True)
    v = x.var(dim=axis, keepdim=True, unbiased=False)
    return (x - m) / torch.sqrt(v + eps)
def _scatter_add(tgt, idx, src, axis=0):
    return tgt.clone().index_add_(axis, idx, src)
def _segment_sum(src, seg, n):
    out = torch.zeros((n,) + src.shape[1:], dtype=src.dtype)
    return out.index_add_(0, seg, src)
def _pad(x, pw):
    flat = tuple(v for pair in reversed(pw) for v in pair)
    return torch.nn.functional.pad(x, flat)

kernel_name = 'concat_heads__mha_block__ssm_conv_s4__prompt'

def setup_inputs():

    _w = (lambda a: (lambda t: t.to(torch.bfloat16) if t.is_floating_point() else t)(torch.as_tensor(a)))
    def _A_setup():
        B, S, D, H = 1, 2048, 448, 16
        return {
            "x": _w((lambda *s: torch.randn(*s, dtype=torch.bfloat16) * 0.2)(B, S, D)),
            "wqkv": _w((lambda *s: torch.randn(*s, dtype=torch.bfloat16) * 0.2)(D, 3 * D)),
            "wo": _w((lambda *s: torch.randn(*s, dtype=torch.bfloat16) * 0.05)(D, D)),
        }
    _A_in = _A_setup()

    def _B_setup():
        B, L, D, N = 1, 2048, 448, 256
        A_re = -(lambda _x: torch.exp(torch.as_tensor(_x)))((lambda *s: torch.randn(*s, dtype=torch.bfloat16) * 3.2)(D, N))
        A_im = torch.pi * (lambda *s: torch.randn(*s, dtype=torch.bfloat16) * 0.05)(D, N)
        B_re = (lambda *s: torch.randn(*s, dtype=torch.bfloat16) * 0.2)(D, N)
        B_im = (lambda *s: torch.randn(*s, dtype=torch.bfloat16) * 0.2)(D, N)
        C_re = (lambda *s: torch.randn(*s, dtype=torch.bfloat16) * 0.2)(D, N)
        C_im = (lambda *s: torch.randn(*s, dtype=torch.bfloat16) * 0.2)(D, N)
        log_dt = (lambda *s: torch.randn(*s, dtype=torch.bfloat16) * 0.05)(D) * 0.5 - 4.0
        Dskip = (lambda *s: torch.randn(*s, dtype=torch.bfloat16) * 0.1)(D)
        return {
            "u": _w((lambda *s: torch.randn(*s, dtype=torch.bfloat16) * 0.05)(B, L, D)),
            "A_re": _w(A_re),
            "A_im": _w(A_im),
            "B_re": _w(B_re),
            "B_im": _w(B_im),
            "C_re": _w(C_re),
            "C_im": _w(C_im),
            "log_dt": _w(log_dt),
            "Dskip": _w(Dskip),
        }
    _B_in = _B_setup()

    return {
        "A_x": _A_in["x"],
        "A_wqkv": _A_in["wqkv"],
        "A_wo": _A_in["wo"],
        "B_u": _B_in["u"],
        "B_A_re": _B_in["A_re"],
        "B_A_im": _B_in["A_im"],
        "B_B_re": _B_in["B_re"],
        "B_B_im": _B_in["B_im"],
        "B_C_re": _B_in["C_re"],
        "B_C_im": _B_in["C_im"],
        "B_log_dt": _B_in["log_dt"],
        "B_Dskip": _B_in["Dskip"],
    }

def reference(A_x, A_wqkv, A_wo, B_u, B_A_re, B_A_im, B_B_re, B_B_im, B_C_re, B_C_im, B_log_dt, B_Dskip):
    def _A_ref(x, wqkv, wo):
        B, S, D = x.shape
        H = 16
        Dh = D // H
        qkv = (lambda x, *d: x.permute(*d))((x @ wqkv).reshape(B, S, 3, H, Dh), 2, 0, 3, 1, 4)
        q, k, v = qkv[0], qkv[1], qkv[2]
        scores = torch.einsum("bhqd,bhkd->bhqk", q, k) * (Dh ** -0.5)
        p = _softmax(scores, axis=-1)
        o = torch.einsum("bhqk,bhkd->bhqd", p, v)
        return (lambda x, *d: x.permute(*d))(o, 0, 2, 1, 3).reshape(B, S, D) @ wo

    def _B_ref(u, A_re, A_im, B_re, B_im, C_re, C_im, log_dt, Dskip):
        Bsz, L, D = u.shape
        dt = torch.exp(log_dt)[:, None]
        A = A_re + 1j * A_im
        Bc = B_re + 1j * B_im
        Cc = C_re + 1j * C_im
        logdA = dt * A
        dB = dt * Bc
        l = (lambda x, dt: x.to(dt))(torch.arange(L), A_re.dtype)
        P = torch.exp(logdA[:, :, None] * l[None, None, :])
        K = torch.einsum("dn,dnl,dn->dl", Cc, P, dB).real
        L2 = 2 * L
        Kp = _pad(K, ((0, 0), (0, L)))
        up = (lambda x, *d: x.permute(*d))(u, 0, 2, 1)
        up = _pad(up, ((0, 0), (0, 0), (0, L)))
        Kf = (lambda x, axes=(-2,-1): torch.fft.rfft2(x.float(), dim=axes))(Kp[:, None, :], axes=(-2, -1))
        Uf = (lambda x, axes=(-2,-1): torch.fft.rfft2(x.float(), dim=axes))(up[:, :, None, :], axes=(-2, -1))
        Yf = Uf * Kf[None, :, :, :]
        y = (lambda x, s, axes=(-2,-1): torch.fft.irfft2(x, s=s, dim=axes).to(torch.bfloat16))(Yf, (1, L2), axes=(-2, -1))[:, :, 0, :L]
        y = (lambda x, *d: x.permute(*d))(y, 0, 2, 1) + u * Dskip[None, None, :]
        return y

    a = _A_ref(A_x, A_wqkv, A_wo)
    b = _B_ref(B_u, B_A_re, B_A_im, B_B_re, B_B_im, B_C_re, B_C_im, B_log_dt, B_Dskip)
    return torch.concatenate([a, b], axis=-1)
```

```asm
; @launch grid=(256,1,1) block=(512,1,1) lds=163840
.amdgcn_target "amdgcn-amd-amdhsa--gfx950"
.text
.globl concat_heads__mha_block__ssm_conv_s4__prompt_kernel
.p2align 8
.type concat_heads__mha_block__ssm_conv_s4__prompt_kernel,@function
concat_heads__mha_block__ssm_conv_s4__prompt_kernel:
  s_load_dwordx2 s[8:9], s[0:1], 0
  s_load_dwordx2 s[12:13], s[0:1], 8
  s_load_dwordx2 s[24:25], s[0:1], 112
  s_load_dwordx8 s[36:43], s[0:1], 32
  s_load_dwordx8 s[44:51], s[0:1], 64
  s_load_dwordx2 s[20:21], s[0:1], 24
  s_load_dwordx2 s[16:17], s[0:1], 16
  s_load_dwordx2 s[28:29], s[0:1], 96
  s_getpc_b64 s[4:5]
PCREF:
  s_cmp_ge_u32 s2, 256
  s_cbranch_scc1 KEND
  s_lshr_b32 s34, s2, 3
  v_lshl_add_u32 v11, s34, 9, v0
  v_lshlrev_b32 v11, 2, v11
  v_min_u32 v11, 39036, v11
  v_mov_b32 v13, s5
  v_add_co_u32 v12, vcc, s4, v11
  v_lshrrev_b32 v11, 6, v0
  v_and_b32 v1, 63, v0
  v_addc_co_u32 v13, vcc, 0, v13, vcc
  v_readfirstlane_b32 s32, v11
  global_load_dword a127, v[12:13], off
  s_and_b32 s33, s2, 7
  s_and_b32 s4, s33, 1
  s_lshl_b32 s3, s4, 3
  s_and_b32 s5, s34, 7
  s_add_u32 s35, s5, s3
  s_lshr_b32 s3, s33, 1
  s_lshl_b32 s3, s3, 2
  s_lshr_b32 s52, s34, 3
  s_add_u32 s52, s52, s3
  s_mov_b32 s11, 0x20000
  s_mov_b32 s15, 0x20000
  s_mov_b32 s26, 12582912
  s_mov_b32 s27, 0x20000
  s_mov_b32 s7, 6684672
  v_lshlrev_b32 v2, 4, v1
  s_cmp_ge_u32 s32, 4
  s_cbranch_scc1 HELPER
  s_setprio 2
  s_add_u32 s3, s4, 1
  s_xor_b32 s57, s5, s3
  s_lshl_b32 s3, s57, 2
  s_lshr_b32 s6, 0x4442567, s3
  s_and_b32 s6, s6, 7
  s_cmp_eq_u32 s4, 1
  s_cselect_b32 s6, 4, s6
  v_lshrrev_b32 v11, 3, v1
  v_and_b32 v12, 7, v1
  v_lshrrev_b32 v13, 4, v1
  v_xor_b32 v14, v12, v13
  v_mul_u32_u24 v3, 896, v11
  v_lshl_add_u32 v3, v14, 4, v3
  s_lshl_b32 s3, s52, 2
  s_add_u32 s3, s3, s32
  s_mul_i32 s3, s3, 28672
  v_add_u32 v3, s3, v3
  v_xor_b32 v4, 64, v3
  v_add_u32 v4, 7168, v4
  v_and_b32 v13, 1, v13
  v_mul_u32_u24 v13, s6, v13
  v_xor_b32 v13, v13, v12
  v_mul_u32_u24 v5, 2688, v11
  v_lshl_add_u32 v5, v13, 4, v5
  s_mul_i32 s3, s32, 43008
  s_mul_i32 s61, s4, 896
  s_add_u32 s3, s3, s61
  s_lshl_b32 s61, s57, 7
  s_add_u32 s3, s3, s61
  s_add_u32 s3, s3, 896
  v_add_u32 v5, s3, v5
  s_mov_b32 s10, 1835008
  s_cmp_eq_u32 s57, 7
  s_cselect_b32 s14, 0, 1204224
  s_lshl_b32 s62, s32, 11
  s_lshl_b32 s63, s32, 12
  s_add_u32 s63, s63, 61440
  s_mov_b32 s84, 14336
  s_waitcnt lgkmcnt(0)
  s_load_dword s60, s[24:25], s7
  s_add_u32 m0, s63, 0
  s_mov_b32 s30, 3670016
  buffer_load_dwordx4 v3, s[8:11], 0 offen offset:0 lds
  s_add_u32 m0, s63, 1024
  s_mov_b32 s31, 0x20000
  buffer_load_dwordx4 v4, s[8:11], 0 offen offset:0 lds
  s_add_u32 m0, s63, 2048
  s_mov_b32 s80, 0
  buffer_load_dwordx4 v3, s[8:11], s84 offen offset:0 lds
  s_mov_b32 s81, -1
  s_mov_b32 s82, 0x0fffffff
  s_mov_b32 s83, 0x0fffffff
  s_and_b32 s54, s34, 3
  s_lshr_b32 s55, s34, 2
  s_lshl_b32 s3, s33, 3
  s_add_u32 s55, s55, s3
  s_mov_b32 s36, 0x76543210
  s_mov_b32 s37, 0xfedcba98
  s_mov_b32 s38, 0
  s_mov_b32 s39, 0
  s_add_u32 m0, s63, 3072
  s_lshl_b32 s3, s4, 3
  buffer_load_dwordx4 v4, s[8:11], s84 offen offset:0 lds
  s_add_u32 s40, s57, s3
  s_cmp_eq_u32 s40, 0
  s_cselect_b32 s36, 0x85743120, s36
  s_cselect_b32 s37, 0xdf6ecab9, s37
  s_cselect_b32 s38, 0x3f205080, s38
  s_cselect_b32 s39, 0x70c6101, s39
  s_cmp_eq_u32 s40, 1
  s_cselect_b32 s36, 0x86753120, s36
  s_cselect_b32 s37, 0xbf4edac9, s37
  s_cselect_b32 s38, 0x3f44e309, s38
  s_cselect_b32 s39, 0xf2d034a, s39
  s_add_u32 m0, s62, 0
  s_mov_b32 s61, 0
  buffer_load_dwordx4 v5, s[12:15], s61 offen lds
  s_cmp_eq_u32 s40, 2
  s_cselect_b32 s36, 0x86754130, s36
  s_cselect_b32 s37, 0x9f2edbca, s37
  s_cselect_b32 s38, 0x3f698552, s38
  s_cselect_b32 s39, 0x174d9594, s39
  s_cmp_eq_u32 s40, 3
  s_cselect_b32 s36, 0xb9a84231, s36
  s_cselect_b32 s37, 0xf7e0d6c5, s37
  s_cselect_b32 s38, 0x1f6de81c, s38
  s_cselect_b32 s39, 0x278e285d, s39
  s_cmp_eq_u32 s40, 4
  s_cselect_b32 s36, 0x75643120, s36
  s_cselect_b32 s37, 0xdfceb9a8, s37
  s_cselect_b32 s38, 0x3fb299a4, s38
  s_cselect_b32 s39, 0x2faeaa25, s39
  s_add_u32 m0, s62, 1024
  s_mov_b32 s61, 21504
  buffer_load_dwordx4 v5, s[12:15], s61 offen lds
  s_cmp_eq_u32 s40, 5
  s_cselect_b32 s36, 0x75643120, s36
  s_cselect_b32 s37, 0xbfaed9c8, s37
  s_cselect_b32 s38, 0x3fd72c2d, s38
  s_cselect_b32 s39, 0x37cf4c6e, s39
  s_cmp_eq_u32 s40, 6
  s_cselect_b32 s36, 0x75643120, s36
  s_cselect_b32 s37, 0xfe8dcab9, s37
  s_cselect_b32 s38, 0x3ffbce76, s38
  s_cselect_b32 s39, 0x3fefdeb8, s39
  s_lshl_b32 s41, s35, 18
  s_lshl_b32 s3, s32, 12
  s_add_u32 m0, s62, 8192
  s_mov_b32 s61, 172032
  buffer_load_dwordx4 v5, s[12:15], s61 offen lds
  s_add_u32 s41, s41, s3
  s_and_b32 s40, s52, 12
  s_add_u32 s3, s40, 0
  s_and_b32 s3, s3, 15
  s_lshl_b32 s3, s3, 14
  s_add_u32 s64, s3, s41
  s_add_u32 s3, s40, 1
  s_and_b32 s3, s3, 15
  s_lshl_b32 s3, s3, 14
  s_add_u32 s65, s3, s41
  s_add_u32 s3, s40, 2
  s_and_b32 s3, s3, 15
  s_add_u32 m0, s62, 9216
  s_mov_b32 s61, 193536
  buffer_load_dwordx4 v5, s[12:15], s61 offen lds
  s_lshl_b32 s3, s3, 14
  s_add_u32 s66, s3, s41
  s_add_u32 s3, s40, 3
  s_and_b32 s3, s3, 15
  s_lshl_b32 s3, s3, 14
  s_add_u32 s67, s3, s41
  s_add_u32 s3, s40, 4
  s_and_b32 s3, s3, 15
  s_lshl_b32 s3, s3, 14
  s_add_u32 s68, s3, s41
  s_add_u32 s3, s40, 5
  s_and_b32 s3, s3, 15
  s_add_u32 m0, s62, 16384
  s_mov_b32 s61, 344064
  buffer_load_dwordx4 v5, s[12:15], s61 offen lds
  s_lshl_b32 s3, s3, 14
  s_add_u32 s69, s3, s41
  s_add_u32 s3, s40, 6
  s_and_b32 s3, s3, 15
  s_lshl_b32 s3, s3, 14
  s_add_u32 s70, s3, s41
  s_add_u32 s3, s40, 7
  s_and_b32 s3, s3, 15
  s_lshl_b32 s3, s3, 14
  s_add_u32 s71, s3, s41
  s_add_u32 s3, s40, 8
  s_and_b32 s3, s3, 15
  s_add_u32 m0, s62, 17408
  s_mov_b32 s61, 365568
  buffer_load_dwordx4 v5, s[12:15], s61 offen lds
  s_lshl_b32 s3, s3, 14
  s_add_u32 s72, s3, s41
  s_add_u32 s3, s40, 9
  s_and_b32 s3, s3, 15
  s_lshl_b32 s3, s3, 14
  s_add_u32 s73, s3, s41
  s_add_u32 s3, s40, 10
  s_and_b32 s3, s3, 15
  s_lshl_b32 s3, s3, 14
  s_add_u32 s74, s3, s41
  s_add_u32 s3, s40, 11
  s_and_b32 s3, s3, 15
  s_add_u32 m0, s63, 16256
  s_lshl_b32 s3, s3, 14
  buffer_load_dwordx4 v3, s[8:11], 0 offen offset:128 lds
  s_add_u32 s75, s3, s41
  s_add_u32 s3, s40, 12
  s_and_b32 s3, s3, 15
  s_lshl_b32 s3, s3, 14
  s_add_u32 s76, s3, s41
  s_add_u32 s3, s40, 13
  s_and_b32 s3, s3, 15
  s_lshl_b32 s3, s3, 14
  s_add_u32 s77, s3, s41
  s_add_u32 s3, s40, 14
  s_and_b32 s3, s3, 15
  s_add_u32 m0, s63, 17280
  s_lshl_b32 s3, s3, 14
  buffer_load_dwordx4 v4, s[8:11], 0 offen offset:128 lds
  s_add_u32 s78, s3, s41
  s_add_u32 s3, s40, 15
  s_and_b32 s3, s3, 15
  s_lshl_b32 s3, s3, 14
  s_add_u32 s79, s3, s41
  v_lshrrev_b32 v11, 5, v1
  v_and_b32 v12, 31, v1
  v_and_b32 v13, 15, v1
  v_lshrrev_b32 v14, 2, v13
  v_lshrrev_b32 v15, 2, v1
  v_and_b32 v15, 4, v15
  s_add_u32 m0, s63, 18304
  v_and_or_b32 v15, v1, 3, v15
  buffer_load_dwordx4 v3, s[8:11], s84 offen offset:128 lds
  v_bfe_u32 v16, v12, 1, 3
  v_xor_b32 v16, v16, v11
  v_lshlrev_b32 v16, 4, v16
  v_lshl_add_u32 v16, v12, 7, v16
  v_add_u32 v6, s63, v16
  v_xor_b32 v7, 32, v6
  v_xor_b32 v8, 64, v6
  v_xor_b32 v9, 96, v6
  v_lshl_add_u32 v16, v11, 3, v14
  v_lshlrev_b32 v17, 2, v15
  v_bfe_u32 v18, v13, 3, 1
  s_add_u32 m0, s63, 19328
  s_lshl_b32 s3, s6, 1
  buffer_load_dwordx4 v4, s[8:11], s84 offen offset:128 lds
  v_mul_u32_u24 v18, s3, v18
  v_bfe_u32 v19, s36, v17, 4
  v_xor_b32 v19, v19, v18
  v_lshlrev_b32 v19, 3, v19
  v_lshl_add_u32 v112, v16, 7, v19
  v_bfe_u32 v19, s37, v17, 4
  v_xor_b32 v19, v19, v18
  v_lshlrev_b32 v19, 3, v19
  v_lshl_add_u32 v113, v16, 7, v19
  v_lshrrev_b32 v17, 2, v1
  v_mul_u32_u24 v114, 2688, v17
  s_add_u32 m0, s63, 32512
  v_and_b32 v17, 3, v1
  buffer_load_dwordx4 v3, s[8:11], 0 offen offset:256 lds
  v_lshl_add_u32 v114, v17, 4, v114
  s_mul_i32 s3, s35, 56
  s_and_b32 s36, s35, 1
  s_lshl_b32 s36, s36, 3
  s_sub_u32 s3, s3, s36
  s_mul_i32 s36, s32, 43008
  s_add_u32 s3, s3, s36
  v_add_u32 v114, s3, v114
  s_lshl_b32 s5, s32, 2
  s_add_u32 s5, s5, 161088
  v_mov_b32 v115, s5
  s_add_u32 m0, s63, 33536
  v_mov_b32 v17, 0
  buffer_load_dwordx4 v4, s[8:11], 0 offen offset:256 lds
  ds_write_b32 v115, v17
  s_lshr_b32 s3, 10752, s35
  s_and_b32 s3, s3, 1
  v_and_b32 v17, 1, v1
  v_bfe_u32 v18, v1, 1, 1
  v_lshl_add_u32 v17, v17, 1, v18
  v_and_or_b32 v17, v15, 4, v17
  v_add_u32 v17, s3, v17
  v_subrev_u32 v18, 7, v17
  v_min_u32 v17, v17, v18
  s_and_b32 s3, s35, 1
  s_add_u32 m0, s63, 34560
  v_add_u32 v17, s3, v17
  buffer_load_dwordx4 v3, s[8:11], s84 offen offset:256 lds
  v_lshlrev_b32 v17, 3, v17
  v_lshl_add_u32 v10, v16, 6, v17
  s_lshl_b32 s42, s52, 2
  s_add_u32 s42, s42, s32
  s_lshl_b32 s42, s42, 12
  s_cmp_eq_u32 s57, 7
  s_cselect_b32 s43, 0x40000000, 0
  s_cmp_eq_u32 s57, 3
  s_cselect_b32 s44, -1, 0
  s_mov_b32 s45, -1
  v_mov_b32 v17, s38
  s_add_u32 m0, s63, 35584
  v_mov_b32 v18, s39
  buffer_load_dwordx4 v4, s[8:11], s84 offen offset:256 lds
  v_cndmask_b32 v17, v17, v18, s[80:81]
  v_lshl_add_u32 v18, v12, 4, s43
  v_bfe_u32 v19, v17, 2, 4
  v_bfe_u32 v20, v17, 0, 2
  v_lshl_add_u32 v19, v19, 18, v18
  v_lshl_add_u32 v116, v20, 9, v19
  v_bfe_u32 v19, v17, 8, 4
  v_bfe_u32 v20, v17, 6, 2
  v_lshl_add_u32 v19, v19, 18, v18
  v_lshl_add_u32 v117, v20, 9, v19
  v_bfe_u32 v19, v17, 14, 4
  s_add_u32 m0, s62, 24576
  s_mov_b32 s61, 516096
  buffer_load_dwordx4 v5, s[12:15], s61 offen lds
  v_bfe_u32 v20, v17, 12, 2
  v_lshl_add_u32 v19, v19, 18, v18
  v_lshl_add_u32 v118, v20, 9, v19
  v_bfe_u32 v19, v17, 20, 4
  v_bfe_u32 v20, v17, 18, 2
  v_lshl_add_u32 v19, v19, 18, v18
  v_lshl_add_u32 v119, v20, 9, v19
  v_bfe_u32 v19, v17, 26, 4
  v_bfe_u32 v20, v17, 24, 2
  v_lshl_add_u32 v19, v19, 18, v18
  v_lshl_add_u32 v120, v20, 9, v19
  s_lshl_b32 s3, s57, 6
  s_add_u32 m0, s62, 25600
  s_mov_b32 s61, 537600
  buffer_load_dwordx4 v5, s[12:15], s61 offen lds
  s_add_u32 s46, s43, 2048
  v_lshl_add_u32 v18, v11, 9, s46
  v_add_u32 v17, s3, v12
  v_mul_u32_u24 v19, 2341, v17
  v_lshrrev_b32 v19, 16, v19
  v_mul_u32_u24 v20, 28, v19
  v_sub_u32 v17, v17, v20
  v_lshl_add_u32 v19, v19, 18, v18
  v_lshl_add_u32 v121, v17, 4, v19
  s_add_u32 s3, s3, 32
  v_add_u32 v17, s3, v12
  v_mul_u32_u24 v19, 2341, v17
  s_add_u32 m0, s62, 32768
  s_mov_b32 s61, 688128
  buffer_load_dwordx4 v5, s[12:15], s61 offen lds
  v_lshrrev_b32 v19, 16, v19
  v_mul_u32_u24 v20, 28, v19
  v_sub_u32 v17, v17, v20
  v_lshl_add_u32 v19, v19, 18, v18
  v_lshl_add_u32 v122, v17, 4, v19
  s_lshl_b32 s3, s57, 2
  s_lshr_b32 s46, 0x0db96420, s3
  s_and_b32 s46, s46, 15
  s_lshl_b32 s46, s46, 2
  s_add_u32 s46, s46, s32
  s_lshl_b32 s46, s46, 10
  s_add_u32 m0, s62, 33792
  s_mov_b32 s61, 709632
  buffer_load_dwordx4 v5, s[12:15], s61 offen lds
  s_lshl_b32 s3, s52, 4
  s_add_u32 s46, s46, s3
  s_lshl_b32 s3, s4, 3
  s_add_u32 s46, s46, s3
  s_add_u32 s46, s46, 6291456
  s_cmp_eq_u32 s57, 0
  s_cselect_b32 s3, 0, 4
  v_and_b32 v13, 3, v1
  v_lshlrev_b32 v13, 8, v13
  v_lshl_add_u32 v13, v14, 12, v13
  v_cmp_eq_u32 vcc, 0, v14
  s_add_u32 m0, s62, 40960
  s_mov_b32 s61, 860160
  buffer_load_dwordx4 v5, s[12:15], s61 offen lds
  v_add_u32 v17, s3, v13
  s_movk_i32 s48, 0xfff
  s_cmp_eq_u32 s57, 3
  s_cselect_b32 s48, 0xffff, s48
  s_cmp_eq_u32 s57, 7
  s_cselect_b32 s48, 15, s48
  s_mov_b32 s49, 0
  v_cndmask_b32 v13, v13, v17, vcc
  v_lshlrev_b32 v15, 2, v1
  s_lshl_b32 s47, s35, 2
  s_add_u32 s47, s47, s32
  s_add_u32 m0, s62, 41984
  s_mov_b32 s61, 881664
  buffer_load_dwordx4 v5, s[12:15], s61 offen lds
  s_lshl_b32 s47, s47, 2
  s_lshr_b32 s3, s52, 2
  s_add_u32 s47, s47, s3
  s_lshl_b32 s47, s47, 8
  s_add_u32 s47, s47, 6291456
  s_bitcmp1_b32 0x2a55, s35
  s_cselect_b32 s50, -1, 0x55555555
  s_mov_b32 s51, s50
  v_add_u32 v123, s63, v2
  s_add_u32 s3, s32, 1
  s_and_b32 s3, s3, 3
  s_add_u32 m0, s62, 49152
  s_mov_b32 s61, 1032192
  buffer_load_dwordx4 v5, s[12:15], s61 offen lds
  s_lshl_b32 s3, s3, 12
  s_add_u32 s3, s3, 61440
  v_add_u32 v124, s3, v2
  s_add_u32 s3, s32, 2
  s_and_b32 s3, s3, 3
  s_lshl_b32 s3, s3, 12
  s_add_u32 s3, s3, 61440
  v_add_u32 v125, s3, v2
  s_add_u32 s3, s32, 3
  s_and_b32 s3, s3, 3
  s_lshl_b32 s3, s3, 12
  s_add_u32 m0, s62, 50176
  s_mov_b32 s61, 1053696
  buffer_load_dwordx4 v5, s[12:15], s61 offen lds
  s_add_u32 s3, s3, 61440
  v_add_u32 v126, s3, v2
  v_mov_b32 v16, 0x3f803f80
  v_accvgpr_write_b32 a120, v16
  v_accvgpr_write_b32 a121, v16
  v_accvgpr_write_b32 a122, v16
  v_accvgpr_write_b32 a123, v16
  v_accvgpr_write_b32 a124, v16
  v_accvgpr_write_b32 a125, v16
  v_accvgpr_write_b32 a126, v16
  v_mov_b32 v127, 0x3f803f80
  s_mov_b32 s14, 1204224
  v_mov_b32 v5, 161088
  s_lshr_b32 s3, s62, 1
  s_add_u32 m0, s3, 57344
  s_mov_b32 s61, 1032192
  buffer_load_dwordx4 v114, s[12:15], s61 offen lds
  s_waitcnt lgkmcnt(0)
  s_add_u32 s56, s60, 0x9E3779B1
  s_cmp_eq_u32 s4, 1
  s_cbranch_scc1 MVVAR
  s_waitcnt vmcnt(23)
  s_waitcnt vmcnt(21)
  s_waitcnt vmcnt(19)
  s_waitcnt vmcnt(17)
  s_barrier
  ds_read_b128 a[0:3], v6 offset:0
  ds_read_b128 a[4:7], v7 offset:0
  ds_read_b128 a[8:11], v8 offset:0
  ds_read_b128 a[12:15], v9 offset:0
  ds_read_b64_tr_b16 v[64:65], v112 offset:0
  ds_read_b64_tr_b16 v[66:67], v112 offset:512
  ds_read_b64_tr_b16 v[68:69], v113 offset:0
  ds_read_b64_tr_b16 v[70:71], v113 offset:512
  ds_read_b64_tr_b16 v[72:73], v112 offset:2048
  ds_read_b64_tr_b16 v[74:75], v112 offset:2560
  ds_read_b64_tr_b16 v[76:77], v113 offset:2048
  ds_read_b64_tr_b16 v[78:79], v113 offset:2560
  ds_read_b64_tr_b16 v[80:81], v112 offset:4096
  ds_read_b64_tr_b16 v[82:83], v112 offset:4608
  ds_read_b64_tr_b16 v[84:85], v113 offset:4096
  ds_read_b64_tr_b16 v[86:87], v113 offset:4608
  ds_read_b64_tr_b16 v[88:89], v112 offset:6144
  ds_read_b64_tr_b16 v[90:91], v112 offset:6656
  ds_read_b64_tr_b16 v[92:93], v113 offset:6144
  ds_read_b64_tr_b16 v[94:95], v113 offset:6656
  s_waitcnt lgkmcnt(15)
  s_add_u32 m0, s63, -384
  s_nop 0
  buffer_load_dwordx4 v3, s[8:11], 0 offen offset:384 lds
  s_add_u32 m0, s63, 640
  s_nop 0
  buffer_load_dwordx4 v4, s[8:11], 0 offen offset:384 lds
  s_add_u32 m0, s63, 1664
  s_nop 0
  buffer_load_dwordx4 v3, s[8:11], s84 offen offset:384 lds
  s_add_u32 m0, s63, 2688
  s_nop 0
  buffer_load_dwordx4 v4, s[8:11], s84 offen offset:384 lds
  s_waitcnt lgkmcnt(12)
  v_mfma_f32_32x32x16_bf16 v[16:31], v[64:67], a[0:3], 0
  v_mfma_f32_32x32x16_bf16 v[32:47], v[68:71], a[0:3], 0
  s_waitcnt lgkmcnt(8)
  v_mfma_f32_32x32x16_bf16 v[16:31], v[72:75], a[4:7], v[16:31]
  v_mfma_f32_32x32x16_bf16 v[32:47], v[76:79], a[4:7], v[32:47]
  s_waitcnt lgkmcnt(4)
  v_mfma_f32_32x32x16_bf16 v[16:31], v[80:83], a[8:11], v[16:31]
  v_mfma_f32_32x32x16_bf16 v[32:47], v[84:87], a[8:11], v[32:47]
  s_waitcnt lgkmcnt(0)
  v_mfma_f32_32x32x16_bf16 v[16:31], v[88:91], a[12:15], v[16:31]
  v_mfma_f32_32x32x16_bf16 v[32:47], v[92:95], a[12:15], v[32:47]
  s_waitcnt vmcnt(17)
  ds_read_b128 a[16:19], v6 offset:16384
  ds_read_b128 a[20:23], v7 offset:16384
  ds_read_b128 a[24:27], v8 offset:16384
  ds_read_b128 a[28:31], v9 offset:16384
  ds_read_b64_tr_b16 v[64:65], v112 offset:8192
  ds_read_b64_tr_b16 v[66:67], v112 offset:8704
  ds_read_b64_tr_b16 v[68:69], v113 offset:8192
  ds_read_b64_tr_b16 v[70:71], v113 offset:8704
  ds_read_b64_tr_b16 v[72:73], v112 offset:10240
  ds_read_b64_tr_b16 v[74:75], v112 offset:10752
  ds_read_b64_tr_b16 v[76:77], v113 offset:10240
  ds_read_b64_tr_b16 v[78:79], v113 offset:10752
  ds_read_b64_tr_b16 v[80:81], v112 offset:12288
  ds_read_b64_tr_b16 v[82:83], v112 offset:12800
  ds_read_b64_tr_b16 v[84:85], v113 offset:12288
  ds_read_b64_tr_b16 v[86:87], v113 offset:12800
  ds_read_b64_tr_b16 v[88:89], v112 offset:14336
  ds_read_b64_tr_b16 v[90:91], v112 offset:14848
  ds_read_b64_tr_b16 v[92:93], v113 offset:14336
  ds_read_b64_tr_b16 v[94:95], v113 offset:14848
  s_waitcnt lgkmcnt(15)
  s_add_u32 m0, s63, 15872
  s_nop 0
  buffer_load_dwordx4 v3, s[8:11], 0 offen offset:512 lds
  s_add_u32 m0, s63, 16896
  s_nop 0
  buffer_load_dwordx4 v4, s[8:11], 0 offen offset:512 lds
  s_add_u32 m0, s63, 17920
  s_nop 0
  buffer_load_dwordx4 v3, s[8:11], s84 offen offset:512 lds
  s_add_u32 m0, s63, 18944
  s_nop 0
  buffer_load_dwordx4 v4, s[8:11], s84 offen offset:512 lds
  s_waitcnt lgkmcnt(12)
  v_mfma_f32_32x32x16_bf16 v[16:31], v[64:67], a[16:19], v[16:31]
  v_mfma_f32_32x32x16_bf16 v[32:47], v[68:71], a[16:19], v[32:47]
  s_waitcnt lgkmcnt(8)
  v_mfma_f32_32x32x16_bf16 v[16:31], v[72:75], a[20:23], v[16:31]
  v_mfma_f32_32x32x16_bf16 v[32:47], v[76:79], a[20:23], v[32:47]
  s_waitcnt lgkmcnt(4)
  v_mfma_f32_32x32x16_bf16 v[16:31], v[80:83], a[24:27], v[16:31]
  v_mfma_f32_32x32x16_bf16 v[32:47], v[84:87], a[24:27], v[32:47]
  s_waitcnt lgkmcnt(0)
  v_mfma_f32_32x32x16_bf16 v[16:31], v[88:91], a[28:31], v[16:31]
  v_mfma_f32_32x32x16_bf16 v[32:47], v[92:95], a[28:31], v[32:47]
  s_waitcnt vmcnt(17)
  s_waitcnt vmcnt(15)
  s_waitcnt vmcnt(13)
  s_waitcnt vmcnt(11)
  s_waitcnt vmcnt(9)
  v_mov_b32 v100, 1
  v_mov_b32 v101, s5
  s_mov_b64 exec, 1
  ds_write_b32 v101, v100
  s_mov_b64 exec, -1
  ds_read_b128 a[32:35], v6 offset:32768
  ds_read_b128 a[36:39], v7 offset:32768
  ds_read_b128 a[40:43], v8 offset:32768
  ds_read_b128 a[44:47], v9 offset:32768
  ds_read_b64_tr_b16 v[64:65], v112 offset:16384
  ds_read_b64_tr_b16 v[66:67], v112 offset:16896
  ds_read_b64_tr_b16 v[68:69], v113 offset:16384
  ds_read_b64_tr_b16 v[70:71], v113 offset:16896
  ds_read_b64_tr_b16 v[72:73], v112 offset:18432
  ds_read_b64_tr_b16 v[74:75], v112 offset:18944
  ds_read_b64_tr_b16 v[76:77], v113 offset:18432
  ds_read_b64_tr_b16 v[78:79], v113 offset:18944
  ds_read_b64_tr_b16 v[80:81], v112 offset:20480
  ds_read_b64_tr_b16 v[82:83], v112 offset:20992
  ds_read_b64_tr_b16 v[84:85], v113 offset:20480
  ds_read_b64_tr_b16 v[86:87], v113 offset:20992
  ds_read_b64_tr_b16 v[88:89], v112 offset:22528
  ds_read_b64_tr_b16 v[90:91], v112 offset:23040
  ds_read_b64_tr_b16 v[92:93], v113 offset:22528
  ds_read_b64_tr_b16 v[94:95], v113 offset:23040
  ds_read_b128 v[96:99], v5
  s_waitcnt lgkmcnt(15)
  s_add_u32 m0, s63, 32128
  s_nop 0
  buffer_load_dwordx4 v3, s[8:11], 0 offen offset:640 lds
  s_add_u32 m0, s63, 33152
  s_nop 0
  buffer_load_dwordx4 v4, s[8:11], 0 offen offset:640 lds
  s_add_u32 m0, s63, 34176
  s_nop 0
  buffer_load_dwordx4 v3, s[8:11], s84 offen offset:640 lds
  s_add_u32 m0, s63, 35200
  s_nop 0
  buffer_load_dwordx4 v4, s[8:11], s84 offen offset:640 lds
  s_waitcnt lgkmcnt(13)
  v_mfma_f32_32x32x16_bf16 v[16:31], v[64:67], a[32:35], v[16:31]
  v_mfma_f32_32x32x16_bf16 v[32:47], v[68:71], a[32:35], v[32:47]
  s_waitcnt lgkmcnt(9)
  v_mfma_f32_32x32x16_bf16 v[16:31], v[72:75], a[36:39], v[16:31]
  v_mfma_f32_32x32x16_bf16 v[32:47], v[76:79], a[36:39], v[32:47]
  s_waitcnt lgkmcnt(5)
  v_mfma_f32_32x32x16_bf16 v[16:31], v[80:83], a[40:43], v[16:31]
  v_mfma_f32_32x32x16_bf16 v[32:47], v[84:87], a[40:43], v[32:47]
  s_waitcnt lgkmcnt(1)
  v_mfma_f32_32x32x16_bf16 v[16:31], v[88:91], a[44:47], v[16:31]
  v_mfma_f32_32x32x16_bf16 v[32:47], v[92:95], a[44:47], v[32:47]
  s_waitcnt lgkmcnt(0)
  v_min3_u32 v96, v96, v97, v98
  v_min_u32 v96, v96, v99
  s_nop 0
  v_readfirstlane_b32 s3, v96
  s_cmp_ge_u32 s3, 1
  s_cbranch_scc0 MMC1
MMC1D:
  s_waitcnt vmcnt(8)
  v_mov_b32 v100, 2
  v_mov_b32 v101, s5
  s_mov_b64 exec, 1
  ds_write_b32 v101, v100
  s_mov_b64 exec, -1
  ds_read_b128 a[48:51], v6 offset:0
  ds_read_b128 a[52:55], v7 offset:0
  ds_read_b128 a[56:59], v8 offset:0
  ds_read_b128 a[60:63], v9 offset:0
  ds_read_b64_tr_b16 v[64:65], v112 offset:24576
  ds_read_b64_tr_b16 v[66:67], v112 offset:25088
  ds_read_b64_tr_b16 v[68:69], v113 offset:24576
  ds_read_b64_tr_b16 v[70:71], v113 offset:25088
  ds_read_b64_tr_b16 v[72:73], v112 offset:26624
  ds_read_b64_tr_b16 v[74:75], v112 offset:27136
  ds_read_b64_tr_b16 v[76:77], v113 offset:26624
  ds_read_b64_tr_b16 v[78:79], v113 offset:27136
  ds_read_b64_tr_b16 v[80:81], v112 offset:28672
  ds_read_b64_tr_b16 v[82:83], v112 offset:29184
  ds_read_b64_tr_b16 v[84:85], v113 offset:28672
  ds_read_b64_tr_b16 v[86:87], v113 offset:29184
  ds_read_b64_tr_b16 v[88:89], v112 offset:30720
  ds_read_b64_tr_b16 v[90:91], v112 offset:31232
  ds_read_b64_tr_b16 v[92:93], v113 offset:30720
  ds_read_b64_tr_b16 v[94:95], v113 offset:31232
  ds_read_b128 v[96:99], v5
  s_waitcnt lgkmcnt(15)
  s_add_u32 m0, s63, -768
  s_nop 0
  buffer_load_dwordx4 v3, s[8:11], 0 offen offset:768 lds
  s_add_u32 m0, s63, 256
  s_nop 0
  buffer_load_dwordx4 v4, s[8:11], 0 offen offset:768 lds
  s_add_u32 m0, s63, 1280
  s_nop 0
  buffer_load_dwordx4 v3, s[8:11], s84 offen offset:768 lds
  s_add_u32 m0, s63, 2304
  s_nop 0
  buffer_load_dwordx4 v4, s[8:11], s84 offen offset:768 lds
  s_waitcnt lgkmcnt(13)
  v_mfma_f32_32x32x16_bf16 v[16:31], v[64:67], a[48:51], v[16:31]
  v_mfma_f32_32x32x16_bf16 v[32:47], v[68:71], a[48:51], v[32:47]
  s_waitcnt lgkmcnt(9)
  v_mfma_f32_32x32x16_bf16 v[16:31], v[72:75], a[52:55], v[16:31]
  v_mfma_f32_32x32x16_bf16 v[32:47], v[76:79], a[52:55], v[32:47]
  s_waitcnt lgkmcnt(5)
  v_mfma_f32_32x32x16_bf16 v[16:31], v[80:83], a[56:59], v[16:31]
  v_mfma_f32_32x32x16_bf16 v[32:47], v[84:87], a[56:59], v[32:47]
  s_waitcnt lgkmcnt(1)
  v_mfma_f32_32x32x16_bf16 v[16:31], v[88:91], a[60:63], v[16:31]
  v_mfma_f32_32x32x16_bf16 v[32:47], v[92:95], a[60:63], v[32:47]
  s_waitcnt lgkmcnt(0)
  v_min3_u32 v96, v96, v97, v98
  v_min_u32 v96, v96, v99
  s_nop 0
  v_readfirstlane_b32 s3, v96
  s_cmp_ge_u32 s3, 2
  s_cbranch_scc0 MMC2
MMC2D:
  s_waitcnt vmcnt(8)
  ds_read_b128 a[64:67], v6 offset:16384
  ds_read_b64_tr_b16 v[64:65], v112 offset:32768
  ds_read_b64_tr_b16 v[66:67], v112 offset:33280
  ds_read_b64_tr_b16 v[68:69], v113 offset:32768
  ds_read_b64_tr_b16 v[70:71], v113 offset:33280
  ds_read_b128 a[68:71], v7 offset:16384
  ds_read_b64_tr_b16 v[72:73], v112 offset:34816
  ds_read_b64_tr_b16 v[74:75], v112 offset:35328
  ds_read_b64_tr_b16 v[76:77], v113 offset:34816
  ds_read_b64_tr_b16 v[78:79], v113 offset:35328
  ds_read_b128 a[72:75], v8 offset:16384
  ds_read_b64_tr_b16 v[80:81], v112 offset:36864
  ds_read_b64_tr_b16 v[82:83], v112 offset:37376
  ds_read_b64_tr_b16 v[84:85], v113 offset:36864
  ds_read_b64_tr_b16 v[86:87], v113 offset:37376
  ds_read_b128 a[76:79], v9 offset:16384
  ds_read_b64_tr_b16 v[88:89], v112 offset:38912
  ds_read_b64_tr_b16 v[90:91], v112 offset:39424
  ds_read_b64_tr_b16 v[92:93], v113 offset:38912
  ds_read_b64_tr_b16 v[94:95], v113 offset:39424
  s_lshr_b32 s3, s62, 1
  s_add_u32 m0, s3, 0
  s_mov_b32 s61, 0
  buffer_load_dwordx4 v114, s[12:15], s61 offen lds
  s_lshr_b32 s3, s62, 1
  s_add_u32 m0, s3, 4096
  s_mov_b32 s61, 172032
  buffer_load_dwordx4 v114, s[12:15], s61 offen lds
  s_lshr_b32 s3, s62, 1
  s_add_u32 m0, s3, 8192
  s_mov_b32 s61, 344064
  buffer_load_dwordx4 v114, s[12:15], s61 offen lds
  s_lshr_b32 s3, s62, 1
  s_add_u32 m0, s3, 12288
  s_mov_b32 s61, 516096
  buffer_load_dwordx4 v114, s[12:15], s61 offen lds
  s_lshr_b32 s3, s62, 1
  s_add_u32 m0, s3, 16384
  s_mov_b32 s61, 688128
  buffer_load_dwordx4 v114, s[12:15], s61 offen lds
  s_lshr_b32 s3, s62, 1
  s_add_u32 m0, s3, 20480
  s_mov_b32 s61, 860160
  buffer_load_dwordx4 v114, s[12:15], s61 offen lds
  s_waitcnt lgkmcnt(15)
  v_mfma_f32_32x32x16_bf16 v[16:31], v[64:67], a[64:67], v[16:31]
  v_mfma_f32_32x32x16_bf16 v[32:47], v[68:71], a[64:67], v[32:47]
  s_waitcnt lgkmcnt(10)
  v_mfma_f32_32x32x16_bf16 v[16:31], v[72:75], a[68:71], v[16:31]
  v_mfma_f32_32x32x16_bf16 v[32:47], v[76:79], a[68:71], v[32:47]
  s_waitcnt lgkmcnt(5)
  v_mfma_f32_32x32x16_bf16 v[16:31], v[80:83], a[72:75], v[16:31]
  v_mfma_f32_32x32x16_bf16 v[32:47], v[84:87], a[72:75], v[32:47]
  s_waitcnt lgkmcnt(0)
  v_mfma_f32_32x32x16_bf16 v[16:31], v[88:91], a[76:79], v[16:31]
  v_mfma_f32_32x32x16_bf16 v[32:47], v[92:95], a[76:79], v[32:47]
  s_waitcnt vmcnt(10)
  ds_read_b128 a[80:83], v6 offset:32768
  ds_read_b64_tr_b16 v[64:65], v112 offset:40960
  ds_read_b64_tr_b16 v[66:67], v112 offset:41472
  ds_read_b64_tr_b16 v[68:69], v113 offset:40960
  ds_read_b64_tr_b16 v[70:71], v113 offset:41472
  ds_read_b128 a[84:87], v7 offset:32768
  ds_read_b64_tr_b16 v[72:73], v112 offset:43008
  ds_read_b64_tr_b16 v[74:75], v112 offset:43520
  ds_read_b64_tr_b16 v[76:77], v113 offset:43008
  ds_read_b64_tr_b16 v[78:79], v113 offset:43520
  ds_read_b128 a[88:91], v8 offset:32768
  ds_read_b64_tr_b16 v[80:81], v112 offset:45056
  ds_read_b64_tr_b16 v[82:83], v112 offset:45568
  ds_read_b64_tr_b16 v[84:85], v113 offset:45056
  ds_read_b64_tr_b16 v[86:87], v113 offset:45568
  ds_read_b128 a[92:95], v9 offset:32768
  ds_read_b64_tr_b16 v[88:89], v112 offset:47104
  ds_read_b64_tr_b16 v[90:91], v112 offset:47616
  ds_read_b64_tr_b16 v[92:93], v113 offset:47104
  ds_read_b64_tr_b16 v[94:95], v113 offset:47616
  s_waitcnt lgkmcnt(15)
  v_mfma_f32_32x32x16_bf16 v[16:31], v[64:67], a[80:83], v[16:31]
  v_mfma_f32_32x32x16_bf16 v[32:47], v[68:71], a[80:83], v[32:47]
  s_waitcnt lgkmcnt(10)
  v_mfma_f32_32x32x16_bf16 v[16:31], v[72:75], a[84:87], v[16:31]
  v_mfma_f32_32x32x16_bf16 v[32:47], v[76:79], a[84:87], v[32:47]
  s_waitcnt lgkmcnt(5)
  v_mfma_f32_32x32x16_bf16 v[16:31], v[80:83], a[88:91], v[16:31]
  v_mfma_f32_32x32x16_bf16 v[32:47], v[84:87], a[88:91], v[32:47]
  s_waitcnt lgkmcnt(0)
  v_mfma_f32_32x32x16_bf16 v[16:31], v[88:91], a[92:95], v[16:31]
  v_mfma_f32_32x32x16_bf16 v[32:47], v[92:95], a[92:95], v[32:47]
  s_waitcnt vmcnt(6)
  ds_read_b128 a[96:99], v6 offset:0
  ds_read_b64_tr_b16 v[64:65], v112 offset:49152
  ds_read_b64_tr_b16 v[66:67], v112 offset:49664
  ds_read_b64_tr_b16 v[68:69], v113 offset:49152
  ds_read_b64_tr_b16 v[70:71], v113 offset:49664
  ds_read_b128 a[100:103], v7 offset:0
  ds_read_b64_tr_b16 v[72:73], v112 offset:51200
  ds_read_b64_tr_b16 v[74:75], v112 offset:51712
  ds_read_b64_tr_b16 v[76:77], v113 offset:51200
  ds_read_b64_tr_b16 v[78:79], v113 offset:51712
  ds_read_b128 a[104:107], v8 offset:0
  ds_read_b64_tr_b16 v[80:81], v112 offset:53248
  ds_read_b64_tr_b16 v[82:83], v112 offset:53760
  ds_read_b64_tr_b16 v[84:85], v113 offset:53248
  ds_read_b64_tr_b16 v[86:87], v113 offset:53760
  ds_read_b128 a[108:111], v9 offset:0
  ds_read_b64_tr_b16 v[88:89], v112 offset:55296
  ds_read_b64_tr_b16 v[90:91], v112 offset:55808
  ds_read_b64_tr_b16 v[92:93], v113 offset:55296
  ds_read_b64_tr_b16 v[94:95], v113 offset:55808
  s_waitcnt lgkmcnt(15)
  v_mfma_f32_32x32x16_bf16 v[16:31], v[64:67], a[96:99], v[16:31]
  v_mfma_f32_32x32x16_bf16 v[32:47], v[68:71], a[96:99], v[32:47]
  s_waitcnt lgkmcnt(10)
  v_mfma_f32_32x32x16_bf16 v[16:31], v[72:75], a[100:103], v[16:31]
  v_mfma_f32_32x32x16_bf16 v[32:47], v[76:79], a[100:103], v[32:47]
  s_waitcnt lgkmcnt(5)
  v_mfma_f32_32x32x16_bf16 v[16:31], v[80:83], a[104:107], v[16:31]
  v_mfma_f32_32x32x16_bf16 v[32:47], v[84:87], a[104:107], v[32:47]
  s_waitcnt lgkmcnt(0)
  v_mfma_f32_32x32x16_bf16 v[16:31], v[88:91], a[108:111], v[16:31]
  v_mfma_f32_32x32x16_bf16 v[32:47], v[92:95], a[108:111], v[32:47]
  s_waitcnt vmcnt(0)
  v_mov_b32 v100, 3
  v_mov_b32 v101, s5
  s_mov_b64 exec, 1
  ds_write_b32 v101, v100
  s_mov_b64 exec, -1
  s_nop 4
  v_cvt_pk_bf16_f32 v48, v16, v17
  v_cvt_pk_bf16_f32 v49, v18, v19
  v_cvt_pk_bf16_f32 v50, v20, v21
  v_cvt_pk_bf16_f32 v51, v22, v23
  v_cvt_pk_bf16_f32 v52, v24, v25
  v_cvt_pk_bf16_f32 v53, v26, v27
  v_cvt_pk_bf16_f32 v54, v28, v29
  v_cvt_pk_bf16_f32 v55, v30, v31
  v_cvt_pk_bf16_f32 v56, v32, v33
  v_cvt_pk_bf16_f32 v57, v34, v35
  v_cvt_pk_bf16_f32 v58, v36, v37
  v_cvt_pk_bf16_f32 v59, v38, v39
  v_cvt_pk_bf16_f32 v60, v40, v41
  v_cvt_pk_bf16_f32 v61, v42, v43
  v_cvt_pk_bf16_f32 v62, v44, v45
  v_cvt_pk_bf16_f32 v63, v46, v47
  ds_read_b128 v[96:99], v5
  buffer_store_dwordx4 v[48:51], v116, s[24:27], s42 offen sc1
  buffer_store_dwordx4 v[52:55], v117, s[24:27], s42 offen sc1
  buffer_store_dwordx4 v[56:59], v118, s[24:27], s42 offen sc1
  buffer_store_dwordx4 v[60:63], v119, s[24:27], s42 offen sc1
  s_mov_b64 exec, s[44:45]
  buffer_store_dwordx4 v[62:65], v120, s[24:27], s42 offen sc1
  s_mov_b64 exec, -1
  s_branch MJOIN
MVVAR:
  s_waitcnt vmcnt(23)
  s_waitcnt vmcnt(21)
  s_waitcnt vmcnt(19)
  s_waitcnt vmcnt(17)
  s_barrier
  ds_read_b128 a[0:3], v6 offset:0
  ds_read_b128 a[4:7], v7 offset:0
  ds_read_b128 a[8:11], v8 offset:0
  ds_read_b128 a[12:15], v9 offset:0
  ds_read_b64_tr_b16 v[64:65], v112 offset:0
  ds_read_b64_tr_b16 v[66:67], v112 offset:512
  ds_read_b64_tr_b16 v[68:69], v113 offset:0
  ds_read_b64_tr_b16 v[70:71], v113 offset:512
  ds_read_b64_tr_b16 v[72:73], v112 offset:2048
  ds_read_b64_tr_b16 v[74:75], v112 offset:2560
  ds_read_b64_tr_b16 v[76:77], v113 offset:2048
  ds_read_b64_tr_b16 v[78:79], v113 offset:2560
  ds_read_b64_tr_b16 v[80:81], v112 offset:4096
  ds_read_b64_tr_b16 v[82:83], v112 offset:4608
  ds_read_b64_tr_b16 v[84:85], v113 offset:4096
  ds_read_b64_tr_b16 v[86:87], v113 offset:4608
  ds_read_b64_tr_b16 v[88:89], v112 offset:6144
  ds_read_b64_tr_b16 v[90:91], v112 offset:6656
  ds_read_b64_tr_b16 v[92:93], v113 offset:6144
  ds_read_b64_tr_b16 v[94:95], v113 offset:6656
  s_waitcnt lgkmcnt(15)
  s_add_u32 m0, s63, -384
  s_nop 0
  buffer_load_dwordx4 v3, s[8:11], 0 offen offset:384 lds
  s_add_u32 m0, s63, 640
  s_nop 0
  buffer_load_dwordx4 v4, s[8:11], 0 offen offset:384 lds
  s_add_u32 m0, s63, 1664
  s_nop 0
  buffer_load_dwordx4 v3, s[8:11], s84 offen offset:384 lds
  s_add_u32 m0, s63, 2688
  s_nop 0
  buffer_load_dwordx4 v4, s[8:11], s84 offen offset:384 lds
  s_waitcnt lgkmcnt(12)
  v_mfma_f32_32x32x16_bf16 v[16:31], a[0:3], v[64:67], 0
  v_mfma_f32_32x32x16_bf16 v[32:47], a[0:3], v[68:71], 0
  s_waitcnt lgkmcnt(8)
  v_mfma_f32_32x32x16_bf16 v[16:31], a[4:7], v[72:75], v[16:31]
  v_mfma_f32_32x32x16_bf16 v[32:47], a[4:7], v[76:79], v[32:47]
  s_waitcnt lgkmcnt(4)
  v_mfma_f32_32x32x16_bf16 v[16:31], a[8:11], v[80:83], v[16:31]
  v_mfma_f32_32x32x16_bf16 v[32:47], a[8:11], v[84:87], v[32:47]
  s_waitcnt lgkmcnt(0)
  v_mfma_f32_32x32x16_bf16 v[16:31], a[12:15], v[88:91], v[16:31]
  v_mfma_f32_32x32x16_bf16 v[32:47], a[12:15], v[92:95], v[32:47]
  s_waitcnt vmcnt(17)
  ds_read_b128 a[16:19], v6 offset:16384
  ds_read_b128 a[20:23], v7 offset:16384
  ds_read_b128 a[24:27], v8 offset:16384
  ds_read_b128 a[28:31], v9 offset:16384
  ds_read_b64_tr_b16 v[64:65], v112 offset:8192
  ds_read_b64_tr_b16 v[66:67], v112 offset:8704
  ds_read_b64_tr_b16 v[68:69], v113 offset:8192
  ds_read_b64_tr_b16 v[70:71], v113 offset:8704
  ds_read_b64_tr_b16 v[72:73], v112 offset:10240
  ds_read_b64_tr_b16 v[74:75], v112 offset:10752
  ds_read_b64_tr_b16 v[76:77], v113 offset:10240
  ds_read_b64_tr_b16 v[78:79], v113 offset:10752
  ds_read_b64_tr_b16 v[80:81], v112 offset:12288
  ds_read_b64_tr_b16 v[82:83], v112 offset:12800
  ds_read_b64_tr_b16 v[84:85], v113 offset:12288
  ds_read_b64_tr_b16 v[86:87], v113 offset:12800
  ds_read_b64_tr_b16 v[88:89], v112 offset:14336
  ds_read_b64_tr_b16 v[90:91], v112 offset:14848
  ds_read_b64_tr_b16 v[92:93], v113 offset:14336
  ds_read_b64_tr_b16 v[94:95], v113 offset:14848
  s_waitcnt lgkmcnt(15)
  s_add_u32 m0, s63, 15872
  s_nop 0
  buffer_load_dwordx4 v3, s[8:11], 0 offen offset:512 lds
  s_add_u32 m0, s63, 16896
  s_nop 0
  buffer_load_dwordx4 v4, s[8:11], 0 offen offset:512 lds
  s_add_u32 m0, s63, 17920
  s_nop 0
  buffer_load_dwordx4 v3, s[8:11], s84 offen offset:512 lds
  s_add_u32 m0, s63, 18944
  s_nop 0
  buffer_load_dwordx4 v4, s[8:11], s84 offen offset:512 lds
  s_waitcnt lgkmcnt(12)
  v_mfma_f32_32x32x16_bf16 v[16:31], a[16:19], v[64:67], v[16:31]
  v_mfma_f32_32x32x16_bf16 v[32:47], a[16:19], v[68:71], v[32:47]
  s_waitcnt lgkmcnt(8)
  v_mfma_f32_32x32x16_bf16 v[16:31], a[20:23], v[72:75], v[16:31]
  v_mfma_f32_32x32x16_bf16 v[32:47], a[20:23], v[76:79], v[32:47]
  s_waitcnt lgkmcnt(4)
  v_mfma_f32_32x32x16_bf16 v[16:31], a[24:27], v[80:83], v[16:31]
  v_mfma_f32_32x32x16_bf16 v[32:47], a[24:27], v[84:87], v[32:47]
  s_waitcnt lgkmcnt(0)
  v_mfma_f32_32x32x16_bf16 v[16:31], a[28:31], v[88:91], v[16:31]
  v_mfma_f32_32x32x16_bf16 v[32:47], a[28:31], v[92:95], v[32:47]
  s_waitcnt vmcnt(17)
  s_waitcnt vmcnt(15)
  s_waitcnt vmcnt(13)
  s_waitcnt vmcnt(11)
  s_waitcnt vmcnt(9)
  v_mov_b32 v100, 1
  v_mov_b32 v101, s5
  s_mov_b64 exec, 1
  ds_write_b32 v101, v100
  s_mov_b64 exec, -1
  ds_read_b128 a[32:35], v6 offset:32768
  ds_read_b128 a[36:39], v7 offset:32768
  ds_read_b128 a[40:43], v8 offset:32768
  ds_read_b128 a[44:47], v9 offset:32768
  ds_read_b64_tr_b16 v[64:65], v112 offset:16384
  ds_read_b64_tr_b16 v[66:67], v112 offset:16896
  ds_read_b64_tr_b16 v[68:69], v113 offset:16384
  ds_read_b64_tr_b16 v[70:71], v113 offset:16896
  ds_read_b64_tr_b16 v[72:73], v112 offset:18432
  ds_read_b64_tr_b16 v[74:75], v112 offset:18944
  ds_read_b64_tr_b16 v[76:77], v113 offset:18432
  ds_read_b64_tr_b16 v[78:79], v113 offset:18944
  ds_read_b64_tr_b16 v[80:81], v112 offset:20480
  ds_read_b64_tr_b16 v[82:83], v112 offset:20992
  ds_read_b64_tr_b16 v[84:85], v113 offset:20480
  ds_read_b64_tr_b16 v[86:87], v113 offset:20992
  ds_read_b64_tr_b16 v[88:89], v112 offset:22528
  ds_read_b64_tr_b16 v[90:91], v112 offset:23040
  ds_read_b64_tr_b16 v[92:93], v113 offset:22528
  ds_read_b64_tr_b16 v[94:95], v113 offset:23040
  ds_read_b128 v[96:99], v5
  s_waitcnt lgkmcnt(15)
  s_add_u32 m0, s63, 32128
  s_nop 0
  buffer_load_dwordx4 v3, s[8:11], 0 offen offset:640 lds
  s_add_u32 m0, s63, 33152
  s_nop 0
  buffer_load_dwordx4 v4, s[8:11], 0 offen offset:640 lds
  s_add_u32 m0, s63, 34176
  s_nop 0
  buffer_load_dwordx4 v3, s[8:11], s84 offen offset:640 lds
  s_add_u32 m0, s63, 35200
  s_nop 0
  buffer_load_dwordx4 v4, s[8:11], s84 offen offset:640 lds
  s_waitcnt lgkmcnt(13)
  v_mfma_f32_32x32x16_bf16 v[16:31], a[32:35], v[64:67], v[16:31]
  v_mfma_f32_32x32x16_bf16 v[32:47], a[32:35], v[68:71], v[32:47]
  s_waitcnt lgkmcnt(9)
  v_mfma_f32_32x32x16_bf16 v[16:31], a[36:39], v[72:75], v[16:31]
  v_mfma_f32_32x32x16_bf16 v[32:47], a[36:39], v[76:79], v[32:47]
  s_waitcnt lgkmcnt(5)
  v_mfma_f32_32x32x16_bf16 v[16:31], a[40:43], v[80:83], v[16:31]
  v_mfma_f32_32x32x16_bf16 v[32:47], a[40:43], v[84:87], v[32:47]
  s_waitcnt lgkmcnt(1)
  v_mfma_f32_32x32x16_bf16 v[16:31], a[44:47], v[88:91], v[16:31]
  v_mfma_f32_32x32x16_bf16 v[32:47], a[44:47], v[92:95], v[32:47]
  s_waitcnt lgkmcnt(0)
  v_min3_u32 v96, v96, v97, v98
  v_min_u32 v96, v96, v99
  s_nop 0
  v_readfirstlane_b32 s3, v96
  s_cmp_ge_u32 s3, 1
  s_cbranch_scc0 MMC3
MMC3D:
  s_waitcnt vmcnt(8)
  v_mov_b32 v100, 2
  v_mov_b32 v101, s5
  s_mov_b64 exec, 1
  ds_write_b32 v101, v100
  s_mov_b64 exec, -1
  ds_read_b128 a[48:51], v6 offset:0
  ds_read_b128 a[52:55], v7 offset:0
  ds_read_b128 a[56:59], v8 offset:0
  ds_read_b128 a[60:63], v9 offset:0
  ds_read_b64_tr_b16 v[64:65], v112 offset:24576
  ds_read_b64_tr_b16 v[66:67], v112 offset:25088
  ds_read_b64_tr_b16 v[68:69], v113 offset:24576
  ds_read_b64_tr_b16 v[70:71], v113 offset:25088
  ds_read_b64_tr_b16 v[72:73], v112 offset:26624
  ds_read_b64_tr_b16 v[74:75], v112 offset:27136
  ds_read_b64_tr_b16 v[76:77], v113 offset:26624
  ds_read_b64_tr_b16 v[78:79], v113 offset:27136
  ds_read_b64_tr_b16 v[80:81], v112 offset:28672
  ds_read_b64_tr_b16 v[82:83], v112 offset:29184
  ds_read_b64_tr_b16 v[84:85], v113 offset:28672
  ds_read_b64_tr_b16 v[86:87], v113 offset:29184
  ds_read_b64_tr_b16 v[88:89], v112 offset:30720
  ds_read_b64_tr_b16 v[90:91], v112 offset:31232
  ds_read_b64_tr_b16 v[92:93], v113 offset:30720
  ds_read_b64_tr_b16 v[94:95], v113 offset:31232
  ds_read_b128 v[96:99], v5
  s_waitcnt lgkmcnt(15)
  s_add_u32 m0, s63, -768
  s_nop 0
  buffer_load_dwordx4 v3, s[8:11], 0 offen offset:768 lds
  s_add_u32 m0, s63, 256
  s_nop 0
  buffer_load_dwordx4 v4, s[8:11], 0 offen offset:768 lds
  s_add_u32 m0, s63, 1280
  s_nop 0
  buffer_load_dwordx4 v3, s[8:11], s84 offen offset:768 lds
  s_add_u32 m0, s63, 2304
  s_nop 0
  buffer_load_dwordx4 v4, s[8:11], s84 offen offset:768 lds
  s_waitcnt lgkmcnt(13)
  v_mfma_f32_32x32x16_bf16 v[16:31], a[48:51], v[64:67], v[16:31]
  v_mfma_f32_32x32x16_bf16 v[32:47], a[48:51], v[68:71], v[32:47]
  s_waitcnt lgkmcnt(9)
  v_mfma_f32_32x32x16_bf16 v[16:31], a[52:55], v[72:75], v[16:31]
  v_mfma_f32_32x32x16_bf16 v[32:47], a[52:55], v[76:79], v[32:47]
  s_waitcnt lgkmcnt(5)
  v_mfma_f32_32x32x16_bf16 v[16:31], a[56:59], v[80:83], v[16:31]
  v_mfma_f32_32x32x16_bf16 v[32:47], a[56:59], v[84:87], v[32:47]
  s_waitcnt lgkmcnt(1)
  v_mfma_f32_32x32x16_bf16 v[16:31], a[60:63], v[88:91], v[16:31]
  v_mfma_f32_32x32x16_bf16 v[32:47], a[60:63], v[92:95], v[32:47]
  s_waitcnt lgkmcnt(0)
  v_min3_u32 v96, v96, v97, v98
  v_min_u32 v96, v96, v99
  s_nop 0
  v_readfirstlane_b32 s3, v96
  s_cmp_ge_u32 s3, 2
  s_cbranch_scc0 MMC4
MMC4D:
  s_waitcnt vmcnt(8)
  ds_read_b128 a[64:67], v6 offset:16384
  ds_read_b64_tr_b16 v[64:65], v112 offset:32768
  ds_read_b64_tr_b16 v[66:67], v112 offset:33280
  ds_read_b64_tr_b16 v[68:69], v113 offset:32768
  ds_read_b64_tr_b16 v[70:71], v113 offset:33280
  ds_read_b128 a[68:71], v7 offset:16384
  ds_read_b64_tr_b16 v[72:73], v112 offset:34816
  ds_read_b64_tr_b16 v[74:75], v112 offset:35328
  ds_read_b64_tr_b16 v[76:77], v113 offset:34816
  ds_read_b64_tr_b16 v[78:79], v113 offset:35328
  ds_read_b128 a[72:75], v8 offset:16384
  ds_read_b64_tr_b16 v[80:81], v112 offset:36864
  ds_read_b64_tr_b16 v[82:83], v112 offset:37376
  ds_read_b64_tr_b16 v[84:85], v113 offset:36864
  ds_read_b64_tr_b16 v[86:87], v113 offset:37376
  ds_read_b128 a[76:79], v9 offset:16384
  ds_read_b64_tr_b16 v[88:89], v112 offset:38912
  ds_read_b64_tr_b16 v[90:91], v112 offset:39424
  ds_read_b64_tr_b16 v[92:93], v113 offset:38912
  ds_read_b64_tr_b16 v[94:95], v113 offset:39424
  s_lshr_b32 s3, s62, 1
  s_add_u32 m0, s3, 0
  s_mov_b32 s61, 0
  buffer_load_dwordx4 v114, s[12:15], s61 offen lds
  s_lshr_b32 s3, s62, 1
  s_add_u32 m0, s3, 4096
  s_mov_b32 s61, 172032
  buffer_load_dwordx4 v114, s[12:15], s61 offen lds
  s_lshr_b32 s3, s62, 1
  s_add_u32 m0, s3, 8192
  s_mov_b32 s61, 344064
  buffer_load_dwordx4 v114, s[12:15], s61 offen lds
  s_lshr_b32 s3, s62, 1
  s_add_u32 m0, s3, 12288
  s_mov_b32 s61, 516096
  buffer_load_dwordx4 v114, s[12:15], s61 offen lds
  s_lshr_b32 s3, s62, 1
  s_add_u32 m0, s3, 16384
  s_mov_b32 s61, 688128
  buffer_load_dwordx4 v114, s[12:15], s61 offen lds
  s_lshr_b32 s3, s62, 1
  s_add_u32 m0, s3, 20480
  s_mov_b32 s61, 860160
  buffer_load_dwordx4 v114, s[12:15], s61 offen lds
  s_waitcnt lgkmcnt(15)
  v_mfma_f32_32x32x16_bf16 v[16:31], a[64:67], v[64:67], v[16:31]
  v_mfma_f32_32x32x16_bf16 v[32:47], a[64:67], v[68:71], v[32:47]
  s_waitcnt lgkmcnt(10)
  v_mfma_f32_32x32x16_bf16 v[16:31], a[68:71], v[72:75], v[16:31]
  v_mfma_f32_32x32x16_bf16 v[32:47], a[68:71], v[76:79], v[32:47]
  s_waitcnt lgkmcnt(5)
  v_mfma_f32_32x32x16_bf16 v[16:31], a[72:75], v[80:83], v[16:31]
  v_mfma_f32_32x32x16_bf16 v[32:47], a[72:75], v[84:87], v[32:47]
  s_waitcnt lgkmcnt(0)
  v_mfma_f32_32x32x16_bf16 v[16:31], a[76:79], v[88:91], v[16:31]
  v_mfma_f32_32x32x16_bf16 v[32:47], a[76:79], v[92:95], v[32:47]
  s_waitcnt vmcnt(10)
  ds_read_b128 a[80:83], v6 offset:32768
  ds_read_b64_tr_b16 v[64:65], v112 offset:40960
  ds_read_b64_tr_b16 v[66:67], v112 offset:41472
  ds_read_b64_tr_b16 v[68:69], v113 offset:40960
  ds_read_b64_tr_b16 v[70:71], v113 offset:41472
  ds_read_b128 a[84:87], v7 offset:32768
  ds_read_b64_tr_b16 v[72:73], v112 offset:43008
  ds_read_b64_tr_b16 v[74:75], v112 offset:43520
  ds_read_b64_tr_b16 v[76:77], v113 offset:43008
  ds_read_b64_tr_b16 v[78:79], v113 offset:43520
  ds_read_b128 a[88:91], v8 offset:32768
  ds_read_b64_tr_b16 v[80:81], v112 offset:45056
  ds_read_b64_tr_b16 v[82:83], v112 offset:45568
  ds_read_b64_tr_b16 v[84:85], v113 offset:45056
  ds_read_b64_tr_b16 v[86:87], v113 offset:45568
  ds_read_b128 a[92:95], v9 offset:32768
  ds_read_b64_tr_b16 v[88:89], v112 offset:47104
  ds_read_b64_tr_b16 v[90:91], v112 offset:47616
  ds_read_b64_tr_b16 v[92:93], v113 offset:47104
  ds_read_b64_tr_b16 v[94:95], v113 offset:47616
  s_waitcnt lgkmcnt(15)
  v_mfma_f32_32x32x16_bf16 v[16:31], a[80:83], v[64:67], v[16:31]
  v_mfma_f32_32x32x16_bf16 v[32:47], a[80:83], v[68:71], v[32:47]
  s_waitcnt lgkmcnt(10)
  v_mfma_f32_32x32x16_bf16 v[16:31], a[84:87], v[72:75], v[16:31]
  v_mfma_f32_32x32x16_bf16 v[32:47], a[84:87], v[76:79], v[32:47]
  s_waitcnt lgkmcnt(5)
  v_mfma_f32_32x32x16_bf16 v[16:31], a[88:91], v[80:83], v[16:31]
  v_mfma_f32_32x32x16_bf16 v[32:47], a[88:91], v[84:87], v[32:47]
  s_waitcnt lgkmcnt(0)
  v_mfma_f32_32x32x16_bf16 v[16:31], a[92:95], v[88:91], v[16:31]
  v_mfma_f32_32x32x16_bf16 v[32:47], a[92:95], v[92:95], v[32:47]
  s_waitcnt vmcnt(6)
  ds_read_b128 a[96:99], v6 offset:0
  ds_read_b64_tr_b16 v[64:65], v112 offset:49152
  ds_read_b64_tr_b16 v[66:67], v112 offset:49664
  ds_read_b64_tr_b16 v[68:69], v113 offset:49152
  ds_read_b64_tr_b16 v[70:71], v113 offset:49664
  ds_read_b128 a[100:103], v7 offset:0
  ds_read_b64_tr_b16 v[72:73], v112 offset:51200
  ds_read_b64_tr_b16 v[74:75], v112 offset:51712
  ds_read_b64_tr_b16 v[76:77], v113 offset:51200
  ds_read_b64_tr_b16 v[78:79], v113 offset:51712
  ds_read_b128 a[104:107], v8 offset:0
  ds_read_b64_tr_b16 v[80:81], v112 offset:53248
  ds_read_b64_tr_b16 v[82:83], v112 offset:53760
  ds_read_b64_tr_b16 v[84:85], v113 offset:53248
  ds_read_b64_tr_b16 v[86:87], v113 offset:53760
  ds_read_b128 a[108:111], v9 offset:0
  ds_read_b64_tr_b16 v[88:89], v112 offset:55296
  ds_read_b64_tr_b16 v[90:91], v112 offset:55808
  ds_read_b64_tr_b16 v[92:93], v113 offset:55296
  ds_read_b64_tr_b16 v[94:95], v113 offset:55808
  s_waitcnt lgkmcnt(15)
  v_mfma_f32_32x32x16_bf16 v[16:31], a[96:99], v[64:67], v[16:31]
  v_mfma_f32_32x32x16_bf16 v[32:47], a[96:99], v[68:71], v[32:47]
  s_waitcnt lgkmcnt(10)
  v_mfma_f32_32x32x16_bf16 v[16:31], a[100:103], v[72:75], v[16:31]
  v_mfma_f32_32x32x16_bf16 v[32:47], a[100:103], v[76:79], v[32:47]
  s_waitcnt lgkmcnt(5)
  v_mfma_f32_32x32x16_bf16 v[16:31], a[104:107], v[80:83], v[16:31]
  v_mfma_f32_32x32x16_bf16 v[32:47], a[104:107], v[84:87], v[32:47]
  s_waitcnt lgkmcnt(0)
  v_mfma_f32_32x32x16_bf16 v[16:31], a[108:111], v[88:91], v[16:31]
  v_mfma_f32_32x32x16_bf16 v[32:47], a[108:111], v[92:95], v[32:47]
  s_waitcnt vmcnt(0)
  v_mov_b32 v100, 3
  v_mov_b32 v101, s5
  s_mov_b64 exec, 1
  ds_write_b32 v101, v100
  s_mov_b64 exec, -1
  s_nop 4
  v_cvt_pk_bf16_f32 v48, v16, v17
  v_cvt_pk_bf16_f32 v49, v18, v19
  v_cvt_pk_bf16_f32 v50, v20, v21
  v_cvt_pk_bf16_f32 v51, v22, v23
  v_cvt_pk_bf16_f32 v52, v24, v25
  v_cvt_pk_bf16_f32 v53, v26, v27
  v_cvt_pk_bf16_f32 v54, v28, v29
  v_cvt_pk_bf16_f32 v55, v30, v31
  v_cvt_pk_bf16_f32 v56, v32, v33
  v_cvt_pk_bf16_f32 v57, v34, v35
  v_cvt_pk_bf16_f32 v58, v36, v37
  v_cvt_pk_bf16_f32 v59, v38, v39
  v_cvt_pk_bf16_f32 v60, v40, v41
  v_cvt_pk_bf16_f32 v61, v42, v43
  v_cvt_pk_bf16_f32 v62, v44, v45
  v_cvt_pk_bf16_f32 v63, v46, v47
  ds_read_b128 v[96:99], v5
  buffer_store_dwordx4 v[48:51], v121, s[24:27], s42 offen offset:0 sc1
  buffer_store_dwordx4 v[52:55], v121, s[24:27], s42 offen offset:1024 sc1
  buffer_store_dwordx4 v[56:59], v122, s[24:27], s42 offen offset:0 sc1
  buffer_store_dwordx4 v[60:63], v122, s[24:27], s42 offen offset:1024 sc1
MJOIN:
  v_accvgpr_write_b32 a127, v127
  s_waitcnt lgkmcnt(0)
  v_min3_u32 v96, v96, v97, v98
  v_min_u32 v96, v96, v99
  s_nop 0
  v_readfirstlane_b32 s3, v96
  s_cmp_ge_u32 s3, 3
  s_cbranch_scc0 MMC5
MMC5D:
  ds_read_b64_tr_b16 v[64:65], v10 offset:0
  ds_read_b64_tr_b16 v[66:67], v10 offset:256
  ds_read_b64_tr_b16 v[68:69], v10 offset:1024
  ds_read_b64_tr_b16 v[70:71], v10 offset:1280
  ds_read_b64_tr_b16 v[72:73], v10 offset:2048
  ds_read_b64_tr_b16 v[74:75], v10 offset:2304
  ds_read_b64_tr_b16 v[76:77], v10 offset:3072
  ds_read_b64_tr_b16 v[78:79], v10 offset:3328
  ds_read_b64_tr_b16 v[80:81], v10 offset:4096
  ds_read_b64_tr_b16 v[82:83], v10 offset:4352
  ds_read_b64_tr_b16 v[84:85], v10 offset:5120
  ds_read_b64_tr_b16 v[86:87], v10 offset:5376
  ds_read_b64_tr_b16 v[88:89], v10 offset:6144
  ds_read_b64_tr_b16 v[90:91], v10 offset:6400
  s_waitcnt lgkmcnt(12)
  v_mfma_f32_32x32x16_bf16 v[96:111], v[64:67], a[0:3], 0
  ds_read_b64_tr_b16 v[92:93], v10 offset:7168
  ds_read_b64_tr_b16 v[94:95], v10 offset:7424
  s_waitcnt lgkmcnt(12)
  v_mfma_f32_32x32x16_bf16 v[96:111], v[68:71], a[4:7], v[96:111]
  ds_read_b64_tr_b16 v[64:65], v10 offset:8192
  ds_read_b64_tr_b16 v[66:67], v10 offset:8448
  s_waitcnt lgkmcnt(12)
  v_mfma_f32_32x32x16_bf16 v[96:111], v[72:75], a[8:11], v[96:111]
  ds_read_b64_tr_b16 v[68:69], v10 offset:9216
  ds_read_b64_tr_b16 v[70:71], v10 offset:9472
  s_waitcnt lgkmcnt(12)
  v_mfma_f32_32x32x16_bf16 v[96:111], v[76:79], a[12:15], v[96:111]
  ds_read_b64_tr_b16 v[72:73], v10 offset:10240
  ds_read_b64_tr_b16 v[74:75], v10 offset:10496
  s_waitcnt lgkmcnt(12)
  v_mfma_f32_32x32x16_bf16 v[96:111], v[80:83], a[16:19], v[96:111]
  ds_read_b64_tr_b16 v[76:77], v10 offset:11264
  ds_read_b64_tr_b16 v[78:79], v10 offset:11520
  s_waitcnt lgkmcnt(12)
  v_mfma_f32_32x32x16_bf16 v[96:111], v[84:87], a[20:23], v[96:111]
  ds_read_b64_tr_b16 v[80:81], v10 offset:12288
  ds_read_b64_tr_b16 v[82:83], v10 offset:12544
  s_waitcnt lgkmcnt(12)
  v_mfma_f32_32x32x16_bf16 v[96:111], v[88:91], a[24:27], v[96:111]
  ds_read_b64_tr_b16 v[84:85], v10 offset:13312
  ds_read_b64_tr_b16 v[86:87], v10 offset:13568
  s_waitcnt lgkmcnt(12)
  v_mfma_f32_32x32x16_bf16 v[96:111], v[92:95], a[28:31], v[96:111]
  ds_read_b64_tr_b16 v[88:89], v10 offset:14336
  ds_read_b64_tr_b16 v[90:91], v10 offset:14592
  s_waitcnt lgkmcnt(12)
  v_mfma_f32_32x32x16_bf16 v[96:111], v[64:67], a[32:35], v[96:111]
  ds_read_b64_tr_b16 v[92:93], v10 offset:15360
  ds_read_b64_tr_b16 v[94:95], v10 offset:15616
  s_waitcnt vmcnt(0)
  v_mov_b32 v12, s56
  s_mov_b64 exec, s[48:49]
  buffer_store_dword v12, v13, s[24:27], s46 offen sc1
  s_mov_b64 exec, -1
  s_waitcnt lgkmcnt(12)
  v_mfma_f32_32x32x16_bf16 v[96:111], v[68:71], a[36:39], v[96:111]
  ds_read_b64_tr_b16 v[64:65], v10 offset:16384
  ds_read_b64_tr_b16 v[66:67], v10 offset:16640
  s_waitcnt lgkmcnt(12)
  v_mfma_f32_32x32x16_bf16 v[96:111], v[72:75], a[40:43], v[96:111]
  ds_read_b64_tr_b16 v[68:69], v10 offset:17408
  ds_read_b64_tr_b16 v[70:71], v10 offset:17664
  s_waitcnt lgkmcnt(12)
  v_mfma_f32_32x32x16_bf16 v[96:111], v[76:79], a[44:47], v[96:111]
  ds_read_b64_tr_b16 v[72:73], v10 offset:18432
  ds_read_b64_tr_b16 v[74:75], v10 offset:18688
  s_waitcnt lgkmcnt(12)
  v_mfma_f32_32x32x16_bf16 v[96:111], v[80:83], a[48:51], v[96:111]
  ds_read_b64_tr_b16 v[76:77], v10 offset:19456
  ds_read_b64_tr_b16 v[78:79], v10 offset:19712
  s_waitcnt lgkmcnt(12)
  v_mfma_f32_32x32x16_bf16 v[96:111], v[84:87], a[52:55], v[96:111]
  ds_read_b64_tr_b16 v[80:81], v10 offset:20480
  ds_read_b64_tr_b16 v[82:83], v10 offset:20736
  s_waitcnt lgkmcnt(12)
  v_mfma_f32_32x32x16_bf16 v[96:111], v[88:91], a[56:59], v[96:111]
  ds_read_b64_tr_b16 v[84:85], v10 offset:21504
  ds_read_b64_tr_b16 v[86:87], v10 offset:21760
  s_waitcnt lgkmcnt(12)
  v_mfma_f32_32x32x16_bf16 v[96:111], v[92:95], a[60:63], v[96:111]
  ds_read_b64_tr_b16 v[88:89], v10 offset:22528
  ds_read_b64_tr_b16 v[90:91], v10 offset:22784
  s_waitcnt lgkmcnt(12)
  v_mfma_f32_32x32x16_bf16 v[96:111], v[64:67], a[64:67], v[96:111]
  ds_read_b64_tr_b16 v[92:93], v10 offset:23552
  ds_read_b64_tr_b16 v[94:95], v10 offset:23808
  v_accvgpr_write_b32 a56, v127
  v_accvgpr_write_b32 a57, v127
  v_accvgpr_write_b32 a58, v127
  v_accvgpr_write_b32 a59, v127
  v_accvgpr_write_b32 a60, v127
  v_accvgpr_write_b32 a61, v127
  v_accvgpr_write_b32 a62, v127
  v_accvgpr_write_b32 a63, v127
  s_waitcnt lgkmcnt(12)
  v_mfma_f32_32x32x16_bf16 v[96:111], v[68:71], a[68:71], v[96:111]
  ds_read_b64_tr_b16 v[64:65], v10 offset:57344
  ds_read_b64_tr_b16 v[66:67], v10 offset:57600
  s_waitcnt lgkmcnt(12)
  v_mfma_f32_32x32x16_bf16 v[96:111], v[72:75], a[72:75], v[96:111]
  ds_read_b64_tr_b16 v[68:69], v10 offset:58368
  ds_read_b64_tr_b16 v[70:71], v10 offset:58624
  s_waitcnt lgkmcnt(12)
  v_mfma_f32_32x32x16_bf16 v[96:111], v[76:79], a[76:79], v[96:111]
  ds_read_b64_tr_b16 v[72:73], v10 offset:59392
  ds_read_b64_tr_b16 v[74:75], v10 offset:59648
  s_waitcnt lgkmcnt(12)
  v_mfma_f32_32x32x16_bf16 v[96:111], v[80:83], a[80:83], v[96:111]
  ds_read_b64_tr_b16 v[76:77], v10 offset:60416
  ds_read_b64_tr_b16 v[78:79], v10 offset:60672
  v_accvgpr_write_b32 a72, v127
  v_accvgpr_write_b32 a73, v127
  v_accvgpr_write_b32 a74, v127
  v_accvgpr_write_b32 a75, v127
  v_accvgpr_write_b32 a76, v127
  v_accvgpr_write_b32 a77, v127
  v_accvgpr_write_b32 a78, v127
  v_accvgpr_write_b32 a79, v127
  s_waitcnt lgkmcnt(12)
  v_mfma_f32_32x32x16_bf16 v[96:111], v[84:87], a[84:87], v[96:111]
  s_waitcnt lgkmcnt(10)
  v_mfma_f32_32x32x16_bf16 v[96:111], v[88:91], a[88:91], v[96:111]
  s_waitcnt lgkmcnt(8)
  v_mfma_f32_32x32x16_bf16 v[96:111], v[92:95], a[92:95], v[96:111]
  s_waitcnt lgkmcnt(6)
  v_mfma_f32_32x32x16_bf16 v[96:111], v[64:67], a[96:99], v[96:111]
  v_accvgpr_write_b32 a88, v127
  v_accvgpr_write_b32 a89, v127
  v_accvgpr_write_b32 a90, v127
  v_accvgpr_write_b32 a91, v127
  v_accvgpr_write_b32 a92, v127
  v_accvgpr_write_b32 a93, v127
  v_accvgpr_write_b32 a94, v127
  v_accvgpr_write_b32 a95, v127
  s_waitcnt lgkmcnt(4)
  v_mfma_f32_32x32x16_bf16 v[96:111], v[68:71], a[100:103], v[96:111]
  s_waitcnt lgkmcnt(2)
  v_mfma_f32_32x32x16_bf16 v[96:111], v[72:75], a[104:107], v[96:111]
  s_waitcnt lgkmcnt(0)
  v_mfma_f32_32x32x16_bf16 v[96:111], v[76:79], a[108:111], v[96:111]
  s_nop 11
  v_mul_f32 v96, 0x3e8b97f6, v96
  v_mul_f32 v97, 0x3e8b97f6, v97
  v_mul_f32 v98, 0x3e8b97f6, v98
  v_mul_f32 v99, 0x3e8b97f6, v99
  v_mul_f32 v100, 0x3e8b97f6, v100
  v_mul_f32 v101, 0x3e8b97f6, v101
  v_mul_f32 v102, 0x3e8b97f6, v102
  v_mul_f32 v103, 0x3e8b97f6, v103
  v_mul_f32 v104, 0x3e8b97f6, v104
  v_mul_f32 v105, 0x3e8b97f6, v105
  v_mul_f32 v106, 0x3e8b97f6, v106
  v_mul_f32 v107, 0x3e8b97f6, v107
  v_mul_f32 v108, 0x3e8b97f6, v108
  v_mul_f32 v109, 0x3e8b97f6, v109
  v_mul_f32 v110, 0x3e8b97f6, v110
  v_mul_f32 v111, 0x3e8b97f6, v111
  v_accvgpr_write_b32 a104, v127
  v_accvgpr_write_b32 a105, v127
  v_accvgpr_write_b32 a106, v127
  v_accvgpr_write_b32 a107, v127
  v_accvgpr_write_b32 a108, v127
  v_accvgpr_write_b32 a109, v127
  v_accvgpr_write_b32 a110, v127
  v_accvgpr_write_b32 a111, v127
  v_cvt_pk_bf16_f32 v112, v96, v97
  v_cvt_pk_bf16_f32 v113, v98, v99
  v_cvt_pk_bf16_f32 v114, v100, v101
  v_cvt_pk_bf16_f32 v115, v102, v103
  v_cvt_pk_bf16_f32 v116, v104, v105
  v_cvt_pk_bf16_f32 v117, v106, v107
  v_cvt_pk_bf16_f32 v118, v108, v109
  v_cvt_pk_bf16_f32 v119, v110, v111
  s_mov_b64 exec, s[80:81]
  v_mov_b32 v118, 0
  v_mov_b32 v119, 0
  s_mov_b64 exec, -1
  ds_write_b128 v123, v[112:115]
  ds_write_b128 v123, v[116:119] offset:1024
  v_mov_b32 v56, 4
  v_mov_b32 v57, s5
  s_mov_b64 exec, 1
  ds_write_b32 v57, v56
  s_mov_b64 exec, -1
  ds_read_b128 v[52:55], v5
  s_waitcnt lgkmcnt(0)
  v_min3_u32 v52, v52, v53, v54
  v_min_u32 v52, v52, v55
  s_nop 0
  v_readfirstlane_b32 s3, v52
  s_cmp_ge_u32 s3, 4
  s_cbranch_scc0 MMC6
MMC6D:
  ds_read_b128 v[16:19], v123 offset:0
  ds_read_b128 v[20:23], v123 offset:1024
  ds_read_b128 v[24:27], v124 offset:0
  ds_read_b128 v[28:31], v124 offset:1024
  ds_read_b128 v[32:35], v125 offset:0
  ds_read_b128 v[36:39], v125 offset:1024
  ds_read_b128 v[40:43], v126 offset:0
  ds_read_b128 v[44:47], v126 offset:1024
  s_mov_b32 s85, 0x8000
MPOLL7:
  buffer_load_dword v48, v15, s[24:27], s47 offen sc1
MPOLL7C:
  s_waitcnt vmcnt(0)
  v_cmp_ne_u32 vcc, s56, v48
  s_and_b64 vcc, vcc, s[50:51]
  s_cbranch_scc0 MPOLL7D
  s_sleep 4
  s_sub_u32 s85, s85, 1
  s_cbranch_scc0 MPOLL7
MPOLL7D:
  s_add_u32 s48, s24, s64
  s_addc_u32 s49, s25, 0
  global_load_dwordx4 a[48:51], v2, s[48:49] offset:0 sc1
  global_load_dwordx4 a[52:55], v2, s[48:49] offset:1024 sc1
  s_mov_b64 exec, s[82:83]
  global_load_dwordx4 a[56:59], v2, s[48:49] offset:2048 sc1
  global_load_dwordx4 a[60:63], v2, s[48:49] offset:3072 sc1
  s_mov_b64 exec, -1
  s_add_u32 s50, s24, s65
  s_addc_u32 s51, s25, 0
  global_load_dwordx4 a[64:67], v2, s[50:51] offset:0 sc1
  global_load_dwordx4 a[68:71], v2, s[50:51] offset:1024 sc1
  s_mov_b64 exec, s[82:83]
  global_load_dwordx4 a[72:75], v2, s[50:51] offset:2048 sc1
  global_load_dwordx4 a[76:79], v2, s[50:51] offset:3072 sc1
  s_mov_b64 exec, -1
  s_add_u32 s3, s32, 1
  s_and_b32 s3, s3, 3
  s_mul_i32 s3, s3, 12288
  s_add_u32 s3, s3, 102400
  v_add_u32 v112, s3, v2
  s_add_u32 s3, s32, 2
  s_and_b32 s3, s3, 3
  s_mul_i32 s3, s3, 12288
  s_add_u32 s3, s3, 106496
  v_add_u32 v113, s3, v2
  s_add_u32 s3, s32, 3
  s_and_b32 s3, s3, 3
  s_mul_i32 s3, s3, 12288
  s_add_u32 s3, s3, 110592
  v_add_u32 v114, s3, v2
  s_mul_i32 s3, s32, 12288
  s_add_u32 s3, s3, 102400
  v_add_u32 v115, s3, v2
  s_mov_b32 s36, 0
  v_and_b32 v12, 1, v1
  v_lshlrev_b32 v12, 3, v12
  v_bfe_u32 v13, v1, 1, 1
  v_lshl_add_u32 v12, v13, 4, v12
  v_add_u32 v12, s36, v12
  v_lshl_add_u32 v124, v14, 5, v12
  v_add_u32 v124, 768, v124
  v_and_b32 v13, 16, v1
  v_lshl_add_u32 v12, v13, 1, v12
  v_lshl_add_u32 v12, v14, 6, v12
  v_mul_u32_u24 v13, 896, v11
  s_add_u32 s3, s32, 0
  s_and_b32 s3, s3, 3
  s_cmp_eq_u32 s3, 3
  s_cselect_b64 vcc, -1, 0
  s_lshl_b32 s3, s3, 8
  v_add_u32 v120, s3, v12
  v_cndmask_b32 v120, v120, v124, vcc
  v_add_u32 v116, v120, v13
  v_add_u32 v117, 50176, v116
  v_add_u32 v121, 50176, v120
  v_and_b32 v12, 31, v1
  s_lshl_b32 s3, s55, 5
  v_add_u32 v12, s3, v12
  v_mul_u32_u24 v124, 1792, v12
  v_lshl_add_u32 v124, v11, 4, v124
  s_mul_i32 s3, s54, 224
  s_lshl_b32 s37, s32, 6
  s_add_u32 s3, s3, s37
  v_add_u32 v124, s3, v124
  v_add_u32 v125, s36, v2
  s_lshl_b32 s3, s52, 2
  s_add_u32 s3, s3, s32
  s_lshl_b32 s3, s3, 4
  s_add_u32 s3, s3, s35
  s_lshl_b32 s40, s3, 11
  s_add_u32 s40, s40, 4194304
  s_lshr_b32 s41, s3, 4
  s_lshl_b32 s41, s41, 11
  s_lshr_b32 s37, s35, 2
  s_lshl_b32 s37, s37, 7
  s_add_u32 s41, s41, s37
  s_and_b32 s37, s35, 3
  s_lshl_b32 s37, s37, 2
  s_add_u32 s41, s41, s37
  s_add_u32 s41, s41, 6553600
  s_lshl_b32 s44, s55, 2
  s_add_u32 s44, s44, s54
  s_lshl_b32 s44, s44, 2
  s_add_u32 s44, s44, s32
  s_lshl_b32 s44, s44, 7
  s_add_u32 s44, s44, 6553600
  s_lshl_b32 s3, s55, 4
  s_lshl_b32 s37, s32, 2
  s_add_u32 s3, s3, s37
  s_lshl_b32 s3, s3, 11
  s_add_u32 s42, s3, 4194304
  s_add_u32 s43, s42, 4096
  v_and_b32 v126, 3, v1
  v_lshlrev_b32 v127, 9, v126
  v_lshlrev_b32 v126, 2, v126
  s_lshl_b32 s3, s32, 2
  s_add_u32 s3, s3, 161088
  v_mov_b32 v8, s3
  v_add_u32 v9, 161088, v126
  v_add_u32 v10, 102400, v2
  s_add_u32 s48, s24, s66
  s_addc_u32 s49, s25, 0
  global_load_dwordx4 a[80:83], v2, s[48:49] offset:0 sc1
  global_load_dwordx4 a[84:87], v2, s[48:49] offset:1024 sc1
  s_mov_b64 exec, s[82:83]
  global_load_dwordx4 a[88:91], v2, s[48:49] offset:2048 sc1
  global_load_dwordx4 a[92:95], v2, s[48:49] offset:3072 sc1
  s_mov_b64 exec, -1
  s_add_u32 s50, s24, s67
  s_addc_u32 s51, s25, 0
  global_load_dwordx4 a[96:99], v2, s[50:51] offset:0 sc1
  global_load_dwordx4 a[100:103], v2, s[50:51] offset:1024 sc1
  s_mov_b64 exec, s[82:83]
  global_load_dwordx4 a[104:107], v2, s[50:51] offset:2048 sc1
  global_load_dwordx4 a[108:111], v2, s[50:51] offset:3072 sc1
  s_mov_b64 exec, -1
  s_add_u32 s48, s24, s68
  s_addc_u32 s49, s25, 0
  global_load_dwordx4 a[112:115], v2, s[48:49] offset:0 sc1
  global_load_dwordx4 a[116:119], v2, s[48:49] offset:1024 sc1
  s_mov_b64 exec, s[82:83]
  global_load_dwordx4 a[120:123], v2, s[48:49] offset:2048 sc1
  global_load_dwordx4 a[124:127], v2, s[48:49] offset:3072 sc1
  s_mov_b64 exec, -1
  s_waitcnt lgkmcnt(0)
  v_mov_b32 v56, 5
  v_mov_b32 v57, s5
  s_mov_b64 exec, 1
  ds_write_b32 v57, v56
  s_mov_b64 exec, -1
  s_waitcnt vmcnt(18)
  s_setprio 0
  v_mfma_f32_32x32x16_bf16 v[48:63], a[48:51], v[24:27], 0
  v_mfma_f32_32x32x16_bf16 v[48:63], a[52:55], v[28:31], v[48:63]
  v_mfma_f32_32x32x16_bf16 v[64:79], a[48:51], v[32:35], 0
  s_nop 10
  v_exp_f32 v48, v48
  v_exp_f32 v49, v49
  v_exp_f32 v50, v50
  v_exp_f32 v51, v51
  v_cvt_pk_bf16_f32 v80, v48, v49
  v_exp_f32 v52, v52
  v_mfma_f32_32x32x16_bf16 v[64:79], a[52:55], v[36:39], v[64:79]
  v_exp_f32 v53, v53
  v_cvt_pk_bf16_f32 v81, v50, v51
  v_exp_f32 v54, v54
  v_exp_f32 v55, v55
  v_cvt_pk_bf16_f32 v82, v52, v53
  v_exp_f32 v56, v56
  v_exp_f32 v57, v57
  v_cvt_pk_bf16_f32 v83, v54, v55
  v_exp_f32 v58, v58
  v_exp_f32 v59, v59
  v_cvt_pk_bf16_f32 v84, v56, v57
  v_exp_f32 v60, v60
  v_exp_f32 v61, v61
  v_cvt_pk_bf16_f32 v85, v58, v59
  v_exp_f32 v62, v62
  v_exp_f32 v63, v63
  v_cvt_pk_bf16_f32 v86, v60, v61
  v_cvt_pk_bf16_f32 v87, v62, v63
  v_mfma_f32_32x32x16_bf16 v[48:63], a[48:51], v[40:43], 0
  v_exp_f32 v64, v64
  v_exp_f32 v65, v65
  v_exp_f32 v66, v66
  v_exp_f32 v67, v67
  v_cvt_pk_bf16_f32 v88, v64, v65
  v_exp_f32 v68, v68
  v_mfma_f32_32x32x16_bf16 v[48:63], a[52:55], v[44:47], v[48:63]
  s_waitcnt vmcnt(16)
  v_exp_f32 v69, v69
  v_cvt_pk_bf16_f32 v89, v66, v67
  v_exp_f32 v70, v70
  v_exp_f32 v71, v71
  v_cvt_pk_bf16_f32 v90, v68, v69
  v_exp_f32 v72, v72
  v_mfma_f32_32x32x16_bf16 a[0:15], a[56:59], v[80:83], 0
  v_exp_f32 v73, v73
  v_cvt_pk_bf16_f32 v91, v70, v71
  v_exp_f32 v74, v74
  v_exp_f32 v75, v75
  v_cvt_pk_bf16_f32 v92, v72, v73
  v_exp_f32 v76, v76
  v_mfma_f32_32x32x16_bf16 a[0:15], a[60:63], v[84:87], a[0:15]
  v_exp_f32 v77, v77
  v_cvt_pk_bf16_f32 v93, v74, v75
  v_exp_f32 v78, v78
  v_exp_f32 v79, v79
  v_cvt_pk_bf16_f32 v94, v76, v77
  v_cvt_pk_bf16_f32 v95, v78, v79
  v_mfma_f32_32x32x16_bf16 v[64:79], a[48:51], v[16:19], 0
  v_exp_f32 v48, v48
  v_exp_f32 v49, v49
  v_exp_f32 v50, v50
  v_exp_f32 v51, v51
  v_cvt_pk_bf16_f32 v80, v48, v49
  v_exp_f32 v52, v52
  v_mfma_f32_32x32x16_bf16 v[64:79], a[52:55], v[20:23], v[64:79]
  s_add_u32 s50, s24, s69
  v_exp_f32 v53, v53
  v_cvt_pk_bf16_f32 v81, v50, v51
  v_exp_f32 v54, v54
  v_exp_f32 v55, v55
  v_cvt_pk_bf16_f32 v82, v52, v53
  v_exp_f32 v56, v56
  v_mfma_f32_32x32x16_bf16 a[16:31], a[56:59], v[88:91], 0
  s_addc_u32 s51, s25, 0
  v_exp_f32 v57, v57
  v_cvt_pk_bf16_f32 v83, v54, v55
  v_exp_f32 v58, v58
  v_exp_f32 v59, v59
  v_cvt_pk_bf16_f32 v84, v56, v57
  v_exp_f32 v60, v60
  v_mfma_f32_32x32x16_bf16 a[16:31], a[60:63], v[92:95], a[16:31]
  s_waitcnt vmcnt(14)
  v_exp_f32 v61, v61
  v_cvt_pk_bf16_f32 v85, v58, v59
  v_exp_f32 v62, v62
  v_exp_f32 v63, v63
  v_cvt_pk_bf16_f32 v86, v60, v61
  v_cvt_pk_bf16_f32 v87, v62, v63
  v_mfma_f32_32x32x16_bf16 v[48:63], a[64:67], v[24:27], 0
  global_load_dwordx4 a[48:51], v2, s[50:51] offset:0 sc1
  v_exp_f32 v64, v64
  v_exp_f32 v65, v65
  v_exp_f32 v66, v66
  v_exp_f32 v67, v67
  v_cvt_pk_bf16_f32 v88, v64, v65
  v_exp_f32 v68, v68
  v_mfma_f32_32x32x16_bf16 v[48:63], a[68:71], v[28:31], v[48:63]
  v_exp_f32 v69, v69
  v_cvt_pk_bf16_f32 v89, v66, v67
  v_exp_f32 v70, v70
  v_exp_f32 v71, v71
  v_cvt_pk_bf16_f32 v90, v68, v69
  v_exp_f32 v72, v72
  v_mfma_f32_32x32x16_bf16 a[32:47], a[56:59], v[80:83], 0
  v_exp_f32 v73, v73
  v_cvt_pk_bf16_f32 v91, v70, v71
  v_exp_f32 v74, v74
  v_exp_f32 v75, v75
  v_cvt_pk_bf16_f32 v92, v72, v73
  v_exp_f32 v76, v76
  v_mfma_f32_32x32x16_bf16 a[32:47], a[60:63], v[84:87], a[32:47]
  v_exp_f32 v77, v77
  v_cvt_pk_bf16_f32 v93, v74, v75
  v_exp_f32 v78, v78
  v_exp_f32 v79, v79
  v_cvt_pk_bf16_f32 v94, v76, v77
  v_cvt_pk_bf16_f32 v95, v78, v79
  v_mfma_f32_32x32x16_bf16 v[64:79], a[64:67], v[32:35], 0
  global_load_dwordx4 a[52:55], v2, s[50:51] offset:1024 sc1
  v_exp_f32 v48, v48
  v_exp_f32 v49, v49
  v_exp_f32 v50, v50
  v_exp_f32 v51, v51
  v_cvt_pk_bf16_f32 v80, v48, v49
  v_exp_f32 v52, v52
  v_mfma_f32_32x32x16_bf16 v[64:79], a[68:71], v[36:39], v[64:79]
  v_exp_f32 v53, v53
  v_cvt_pk_bf16_f32 v81, v50, v51
  v_exp_f32 v54, v54
  v_exp_f32 v55, v55
  v_cvt_pk_bf16_f32 v82, v52, v53
  v_exp_f32 v56, v56
  v_mfma_f32_32x32x16_bf16 v[96:111], a[56:59], v[88:91], 0
  v_exp_f32 v57, v57
  v_cvt_pk_bf16_f32 v83, v54, v55
  v_exp_f32 v58, v58
  v_exp_f32 v59, v59
  v_cvt_pk_bf16_f32 v84, v56, v57
  v_exp_f32 v60, v60
  v_mfma_f32_32x32x16_bf16 v[96:111], a[60:63], v[92:95], v[96:111]
  v_exp_f32 v61, v61
  v_cvt_pk_bf16_f32 v85, v58, v59
  v_exp_f32 v62, v62
  v_exp_f32 v63, v63
  v_cvt_pk_bf16_f32 v86, v60, v61
  v_cvt_pk_bf16_f32 v87, v62, v63
  v_mfma_f32_32x32x16_bf16 v[48:63], a[64:67], v[40:43], 0
  s_mov_b64 exec, s[82:83]
  global_load_dwordx4 a[56:59], v2, s[50:51] offset:2048 sc1
  global_load_dwordx4 a[60:63], v2, s[50:51] offset:3072 sc1
  s_mov_b64 exec, -1
  v_exp_f32 v64, v64
  v_exp_f32 v65, v65
  v_exp_f32 v66, v66
  v_exp_f32 v67, v67
  v_cvt_pk_bf16_f32 v88, v64, v65
  v_exp_f32 v68, v68
  v_mfma_f32_32x32x16_bf16 v[48:63], a[68:71], v[44:47], v[48:63]
  s_waitcnt vmcnt(16)
  v_exp_f32 v69, v69
  v_cvt_pk_bf16_f32 v89, v66, v67
  v_exp_f32 v70, v70
  v_exp_f32 v71, v71
  v_cvt_pk_bf16_f32 v90, v68, v69
  v_exp_f32 v72, v72
  v_mfma_f32_32x32x16_bf16 a[0:15], a[72:75], v[80:83], a[0:15]
  v_exp_f32 v73, v73
  v_cvt_pk_bf16_f32 v91, v70, v71
  v_exp_f32 v74, v74
  v_exp_f32 v75, v75
  v_cvt_pk_bf16_f32 v92, v72, v73
  v_exp_f32 v76, v76
  v_mfma_f32_32x32x16_bf16 a[0:15], a[76:79], v[84:87], a[0:15]
  v_exp_f32 v77, v77
  v_cvt_pk_bf16_f32 v93, v74, v75
  v_exp_f32 v78, v78
  v_exp_f32 v79, v79
  v_cvt_pk_bf16_f32 v94, v76, v77
  v_cvt_pk_bf16_f32 v95, v78, v79
  v_mfma_f32_32x32x16_bf16 v[64:79], a[64:67], v[16:19], 0
  v_exp_f32 v48, v48
  v_exp_f32 v49, v49
  v_exp_f32 v50, v50
  v_exp_f32 v51, v51
  v_cvt_pk_bf16_f32 v80, v48, v49
  v_exp_f32 v52, v52
  v_mfma_f32_32x32x16_bf16 v[64:79], a[68:71], v[20:23], v[64:79]
  s_add_u32 s48, s24, s70
  v_exp_f32 v53, v53
  v_cvt_pk_bf16_f32 v81, v50, v51
  v_exp_f32 v54, v54
  v_exp_f32 v55, v55
  v_cvt_pk_bf16_f32 v82, v52, v53
  v_exp_f32 v56, v56
  v_mfma_f32_32x32x16_bf16 a[16:31], a[72:75], v[88:91], a[16:31]
  s_addc_u32 s49, s25, 0
  v_exp_f32 v57, v57
  v_cvt_pk_bf16_f32 v83, v54, v55
  v_exp_f32 v58, v58
  v_exp_f32 v59, v59
  v_cvt_pk_bf16_f32 v84, v56, v57
  v_exp_f32 v60, v60
  v_mfma_f32_32x32x16_bf16 a[16:31], a[76:79], v[92:95], a[16:31]
  s_waitcnt vmcnt(14)
  v_exp_f32 v61, v61
  v_cvt_pk_bf16_f32 v85, v58, v59
  v_exp_f32 v62, v62
  v_exp_f32 v63, v63
  v_cvt_pk_bf16_f32 v86, v60, v61
  v_cvt_pk_bf16_f32 v87, v62, v63
  v_mfma_f32_32x32x16_bf16 v[48:63], a[80:83], v[24:27], 0
  global_load_dwordx4 a[64:67], v2, s[48:49] offset:0 sc1
  v_exp_f32 v64, v64
  v_exp_f32 v65, v65
  v_exp_f32 v66, v66
  v_exp_f32 v67, v67
  v_cvt_pk_bf16_f32 v88, v64, v65
  v_exp_f32 v68, v68
  v_mfma_f32_32x32x16_bf16 v[48:63], a[84:87], v[28:31], v[48:63]
  v_exp_f32 v69, v69
  v_cvt_pk_bf16_f32 v89, v66, v67
  v_exp_f32 v70, v70
  v_exp_f32 v71, v71
  v_cvt_pk_bf16_f32 v90, v68, v69
  v_exp_f32 v72, v72
  v_mfma_f32_32x32x16_bf16 a[32:47], a[72:75], v[80:83], a[32:47]
  v_exp_f32 v73, v73
  v_cvt_pk_bf16_f32 v91, v70, v71
  v_exp_f32 v74, v74
  v_exp_f32 v75, v75
  v_cvt_pk_bf16_f32 v92, v72, v73
  v_exp_f32 v76, v76
  v_mfma_f32_32x32x16_bf16 a[32:47], a[76:79], v[84:87], a[32:47]
  v_exp_f32 v77, v77
  v_cvt_pk_bf16_f32 v93, v74, v75
  v_exp_f32 v78, v78
  v_exp_f32 v79, v79
  v_cvt_pk_bf16_f32 v94, v76, v77
  v_cvt_pk_bf16_f32 v95, v78, v79
  v_mfma_f32_32x32x16_bf16 v[64:79], a[80:83], v[32:35], 0
  global_load_dwordx4 a[68:71], v2, s[48:49] offset:1024 sc1
  v_exp_f32 v48, v48
  v_exp_f32 v49, v49
  v_exp_f32 v50, v50
  v_exp_f32 v51, v51
  v_cvt_pk_bf16_f32 v80, v48, v49
  v_exp_f32 v52, v52
  v_mfma_f32_32x32x16_bf16 v[64:79], a[84:87], v[36:39], v[64:79]
  v_exp_f32 v53, v53
  v_cvt_pk_bf16_f32 v81, v50, v51
  v_exp_f32 v54, v54
  v_exp_f32 v55, v55
  v_cvt_pk_bf16_f32 v82, v52, v53
  v_exp_f32 v56, v56
  v_mfma_f32_32x32x16_bf16 v[96:111], a[72:75], v[88:91], v[96:111]
  v_exp_f32 v57, v57
  v_cvt_pk_bf16_f32 v83, v54, v55
  v_exp_f32 v58, v58
  v_exp_f32 v59, v59
  v_cvt_pk_bf16_f32 v84, v56, v57
  v_exp_f32 v60, v60
  v_mfma_f32_32x32x16_bf16 v[96:111], a[76:79], v[92:95], v[96:111]
  v_exp_f32 v61, v61
  v_cvt_pk_bf16_f32 v85, v58, v59
  v_exp_f32 v62, v62
  v_exp_f32 v63, v63
  v_cvt_pk_bf16_f32 v86, v60, v61
  v_cvt_pk_bf16_f32 v87, v62, v63
  v_mfma_f32_32x32x16_bf16 v[48:63], a[80:83], v[40:43], 0
  s_mov_b64 exec, s[82:83]
  global_load_dwordx4 a[72:75], v2, s[48:49] offset:2048 sc1
  global_load_dwordx4 a[76:79], v2, s[48:49] offset:3072 sc1
  s_mov_b64 exec, -1
  v_exp_f32 v64, v64
  v_exp_f32 v65, v65
  v_exp_f32 v66, v66
  v_exp_f32 v67, v67
  v_cvt_pk_bf16_f32 v88, v64, v65
  v_exp_f32 v68, v68
  v_mfma_f32_32x32x16_bf16 v[48:63], a[84:87], v[44:47], v[48:63]
  s_waitcnt vmcnt(16)
  v_exp_f32 v69, v69
  v_cvt_pk_bf16_f32 v89, v66, v67
  v_exp_f32 v70, v70
  v_exp_f32 v71, v71
  v_cvt_pk_bf16_f32 v90, v68, v69
  v_exp_f32 v72, v72
  v_mfma_f32_32x32x16_bf16 a[0:15], a[88:91], v[80:83], a[0:15]
  v_exp_f32 v73, v73
  v_cvt_pk_bf16_f32 v91, v70, v71
  v_exp_f32 v74, v74
  v_exp_f32 v75, v75
  v_cvt_pk_bf16_f32 v92, v72, v73
  v_exp_f32 v76, v76
  v_mfma_f32_32x32x16_bf16 a[0:15], a[92:95], v[84:87], a[0:15]
  v_exp_f32 v77, v77
  v_cvt_pk_bf16_f32 v93, v74, v75
  v_exp_f32 v78, v78
  v_exp_f32 v79, v79
  v_cvt_pk_bf16_f32 v94, v76, v77
  v_cvt_pk_bf16_f32 v95, v78, v79
  v_mfma_f32_32x32x16_bf16 v[64:79], a[80:83], v[16:19], 0
  v_exp_f32 v48, v48
  v_exp_f32 v49, v49
  v_exp_f32 v50, v50
  v_exp_f32 v51, v51
  v_cvt_pk_bf16_f32 v80, v48, v49
  v_exp_f32 v52, v52
  v_mfma_f32_32x32x16_bf16 v[64:79], a[84:87], v[20:23], v[64:79]
  s_add_u32 s50, s24, s71
  v_mov_b32 v12, -1
  v_mov_b32 v13, -1
  v_exp_f32 v53, v53
  v_cvt_pk_bf16_f32 v81, v50, v51
  v_exp_f32 v54, v54
  v_exp_f32 v55, v55
  v_cvt_pk_bf16_f32 v82, v52, v53
  v_exp_f32 v56, v56
  v_mfma_f32_32x32x16_bf16 a[16:31], a[88:91], v[88:91], a[16:31]
  s_addc_u32 s51, s25, 0
  v_mov_b32 v14, -1
  v_mov_b32 v15, -1
  v_exp_f32 v57, v57
  v_cvt_pk_bf16_f32 v83, v54, v55
  v_exp_f32 v58, v58
  v_exp_f32 v59, v59
  v_cvt_pk_bf16_f32 v84, v56, v57
  v_exp_f32 v60, v60
  v_mfma_f32_32x32x16_bf16 a[16:31], a[92:95], v[92:95], a[16:31]
  s_waitcnt vmcnt(14)
  v_exp_f32 v61, v61
  v_cvt_pk_bf16_f32 v85, v58, v59
  v_exp_f32 v62, v62
  v_exp_f32 v63, v63
  v_cvt_pk_bf16_f32 v86, v60, v61
  v_cvt_pk_bf16_f32 v87, v62, v63
  v_mfma_f32_32x32x16_bf16 v[48:63], a[96:99], v[24:27], 0
  global_load_dwordx4 a[80:83], v2, s[50:51] offset:0 sc1
  v_exp_f32 v64, v64
  v_exp_f32 v65, v65
  v_exp_f32 v66, v66
  v_exp_f32 v67, v67
  v_cvt_pk_bf16_f32 v88, v64, v65
  v_exp_f32 v68, v68
  v_mfma_f32_32x32x16_bf16 v[48:63], a[100:103], v[28:31], v[48:63]
  v_exp_f32 v69, v69
  v_cvt_pk_bf16_f32 v89, v66, v67
  v_exp_f32 v70, v70
  v_exp_f32 v71, v71
  v_cvt_pk_bf16_f32 v90, v68, v69
  v_exp_f32 v72, v72
  v_mfma_f32_32x32x16_bf16 a[32:47], a[88:91], v[80:83], a[32:47]
  buffer_store_dwordx4 v[12:15], v2, s[24:27], s40 offen offset:0 sc1
  v_exp_f32 v73, v73
  v_cvt_pk_bf16_f32 v91, v70, v71
  v_exp_f32 v74, v74
  v_exp_f32 v75, v75
  v_cvt_pk_bf16_f32 v92, v72, v73
  v_exp_f32 v76, v76
  v_mfma_f32_32x32x16_bf16 a[32:47], a[92:95], v[84:87], a[32:47]
  v_exp_f32 v77, v77
  v_cvt_pk_bf16_f32 v93, v74, v75
  v_exp_f32 v78, v78
  v_exp_f32 v79, v79
  v_cvt_pk_bf16_f32 v94, v76, v77
  v_cvt_pk_bf16_f32 v95, v78, v79
  v_mfma_f32_32x32x16_bf16 v[64:79], a[96:99], v[32:35], 0
  global_load_dwordx4 a[84:87], v2, s[50:51] offset:1024 sc1
  v_exp_f32 v48, v48
  v_exp_f32 v49, v49
  v_exp_f32 v50, v50
  v_exp_f32 v51, v51
  v_cvt_pk_bf16_f32 v80, v48, v49
  v_exp_f32 v52, v52
  v_mfma_f32_32x32x16_bf16 v[64:79], a[100:103], v[36:39], v[64:79]
  v_exp_f32 v53, v53
  v_cvt_pk_bf16_f32 v81, v50, v51
  v_exp_f32 v54, v54
  v_exp_f32 v55, v55
  v_cvt_pk_bf16_f32 v82, v52, v53
  v_exp_f32 v56, v56
  v_mfma_f32_32x32x16_bf16 v[96:111], a[88:91], v[88:91], v[96:111]
  buffer_store_dwordx4 v[12:15], v2, s[24:27], s40 offen offset:1024 sc1
  v_exp_f32 v57, v57
  v_cvt_pk_bf16_f32 v83, v54, v55
  v_exp_f32 v58, v58
  v_exp_f32 v59, v59
  v_cvt_pk_bf16_f32 v84, v56, v57
  v_exp_f32 v60, v60
  v_mfma_f32_32x32x16_bf16 v[96:111], a[92:95], v[92:95], v[96:111]
  v_exp_f32 v61, v61
  v_cvt_pk_bf16_f32 v85, v58, v59
  v_exp_f32 v62, v62
  v_exp_f32 v63, v63
  v_cvt_pk_bf16_f32 v86, v60, v61
  v_cvt_pk_bf16_f32 v87, v62, v63
  v_mfma_f32_32x32x16_bf16 v[48:63], a[96:99], v[40:43], 0
  s_mov_b64 exec, s[82:83]
  global_load_dwordx4 a[88:91], v2, s[50:51] offset:2048 sc1
  global_load_dwordx4 a[92:95], v2, s[50:51] offset:3072 sc1
  s_mov_b64 exec, -1
  v_exp_f32 v64, v64
  v_exp_f32 v65, v65
  v_exp_f32 v66, v66
  v_exp_f32 v67, v67
  v_cvt_pk_bf16_f32 v88, v64, v65
  v_exp_f32 v68, v68
  v_mfma_f32_32x32x16_bf16 v[48:63], a[100:103], v[44:47], v[48:63]
  s_waitcnt vmcnt(18)
  v_exp_f32 v69, v69
  v_cvt_pk_bf16_f32 v89, v66, v67
  v_exp_f32 v70, v70
  v_exp_f32 v71, v71
  v_cvt_pk_bf16_f32 v90, v68, v69
  v_exp_f32 v72, v72
  v_mfma_f32_32x32x16_bf16 a[0:15], a[104:107], v[80:83], a[0:15]
  v_exp_f32 v73, v73
  v_cvt_pk_bf16_f32 v91, v70, v71
  v_exp_f32 v74, v74
  v_exp_f32 v75, v75
  v_cvt_pk_bf16_f32 v92, v72, v73
  v_exp_f32 v76, v76
  v_mfma_f32_32x32x16_bf16 a[0:15], a[108:111], v[84:87], a[0:15]
  v_exp_f32 v77, v77
  v_cvt_pk_bf16_f32 v93, v74, v75
  v_exp_f32 v78, v78
  v_exp_f32 v79, v79
  v_cvt_pk_bf16_f32 v94, v76, v77
  v_cvt_pk_bf16_f32 v95, v78, v79
  v_mfma_f32_32x32x16_bf16 v[64:79], a[96:99], v[16:19], 0
  v_exp_f32 v48, v48
  v_exp_f32 v49, v49
  v_exp_f32 v50, v50
  v_exp_f32 v51, v51
  v_cvt_pk_bf16_f32 v80, v48, v49
  v_exp_f32 v52, v52
  v_mfma_f32_32x32x16_bf16 v[64:79], a[100:103], v[20:23], v[64:79]
  s_add_u32 s48, s24, s72
  v_exp_f32 v53, v53
  v_cvt_pk_bf16_f32 v81, v50, v51
  v_exp_f32 v54, v54
  v_exp_f32 v55, v55
  v_cvt_pk_bf16_f32 v82, v52, v53
  v_exp_f32 v56, v56
  v_mfma_f32_32x32x16_bf16 a[16:31], a[104:107], v[88:91], a[16:31]
  s_addc_u32 s49, s25, 0
  v_exp_f32 v57, v57
  v_cvt_pk_bf16_f32 v83, v54, v55
  v_exp_f32 v58, v58
  v_exp_f32 v59, v59
  v_cvt_pk_bf16_f32 v84, v56, v57
  v_exp_f32 v60, v60
  v_mfma_f32_32x32x16_bf16 a[16:31], a[108:111], v[92:95], a[16:31]
  s_waitcnt vmcnt(16)
  v_exp_f32 v61, v61
  v_cvt_pk_bf16_f32 v85, v58, v59
  v_exp_f32 v62, v62
  v_exp_f32 v63, v63
  v_cvt_pk_bf16_f32 v86, v60, v61
  v_cvt_pk_bf16_f32 v87, v62, v63
  v_mfma_f32_32x32x16_bf16 v[48:63], a[112:115], v[24:27], 0
  global_load_dwordx4 a[96:99], v2, s[48:49] offset:0 sc1
  v_exp_f32 v64, v64
  v_exp_f32 v65, v65
  v_exp_f32 v66, v66
  v_exp_f32 v67, v67
  v_cvt_pk_bf16_f32 v88, v64, v65
  v_exp_f32 v68, v68
  v_mfma_f32_32x32x16_bf16 v[48:63], a[116:119], v[28:31], v[48:63]
  v_exp_f32 v69, v69
  v_cvt_pk_bf16_f32 v89, v66, v67
  v_exp_f32 v70, v70
  v_exp_f32 v71, v71
  v_cvt_pk_bf16_f32 v90, v68, v69
  v_exp_f32 v72, v72
  v_mfma_f32_32x32x16_bf16 a[32:47], a[104:107], v[80:83], a[32:47]
  v_exp_f32 v73, v73
  v_cvt_pk_bf16_f32 v91, v70, v71
  v_exp_f32 v74, v74
  v_exp_f32 v75, v75
  v_cvt_pk_bf16_f32 v92, v72, v73
  v_exp_f32 v76, v76
  v_mfma_f32_32x32x16_bf16 a[32:47], a[108:111], v[84:87], a[32:47]
  v_exp_f32 v77, v77
  v_cvt_pk_bf16_f32 v93, v74, v75
  v_exp_f32 v78, v78
  v_exp_f32 v79, v79
  v_cvt_pk_bf16_f32 v94, v76, v77
  v_cvt_pk_bf16_f32 v95, v78, v79
  v_mfma_f32_32x32x16_bf16 v[64:79], a[112:115], v[32:35], 0
  global_load_dwordx4 a[100:103], v2, s[48:49] offset:1024 sc1
  v_exp_f32 v48, v48
  v_exp_f32 v49, v49
  v_exp_f32 v50, v50
  v_exp_f32 v51, v51
  v_cvt_pk_bf16_f32 v80, v48, v49
  v_exp_f32 v52, v52
  v_mfma_f32_32x32x16_bf16 v[64:79], a[116:119], v[36:39], v[64:79]
  v_exp_f32 v53, v53
  v_cvt_pk_bf16_f32 v81, v50, v51
  v_exp_f32 v54, v54
  v_exp_f32 v55, v55
  v_cvt_pk_bf16_f32 v82, v52, v53
  v_exp_f32 v56, v56
  v_mfma_f32_32x32x16_bf16 v[96:111], a[104:107], v[88:91], v[96:111]
  v_exp_f32 v57, v57
  v_cvt_pk_bf16_f32 v83, v54, v55
  v_exp_f32 v58, v58
  v_exp_f32 v59, v59
  v_cvt_pk_bf16_f32 v84, v56, v57
  v_exp_f32 v60, v60
  v_mfma_f32_32x32x16_bf16 v[96:111], a[108:111], v[92:95], v[96:111]
  v_exp_f32 v61, v61
  v_cvt_pk_bf16_f32 v85, v58, v59
  v_exp_f32 v62, v62
  v_exp_f32 v63, v63
  v_cvt_pk_bf16_f32 v86, v60, v61
  v_cvt_pk_bf16_f32 v87, v62, v63
  v_mfma_f32_32x32x16_bf16 v[48:63], a[112:115], v[40:43], 0
  s_mov_b64 exec, s[82:83]
  global_load_dwordx4 a[104:107], v2, s[48:49] offset:2048 sc1
  global_load_dwordx4 a[108:111], v2, s[48:49] offset:3072 sc1
  s_mov_b64 exec, -1
  v_exp_f32 v64, v64
  v_exp_f32 v65, v65
  v_exp_f32 v66, v66
  v_exp_f32 v67, v67
  v_cvt_pk_bf16_f32 v88, v64, v65
  v_exp_f32 v68, v68
  v_mfma_f32_32x32x16_bf16 v[48:63], a[116:119], v[44:47], v[48:63]
  s_waitcnt vmcnt(18)
  v_exp_f32 v69, v69
  v_cvt_pk_bf16_f32 v89, v66, v67
  v_exp_f32 v70, v70
  v_exp_f32 v71, v71
  v_cvt_pk_bf16_f32 v90, v68, v69
  v_exp_f32 v72, v72
  v_mfma_f32_32x32x16_bf16 a[0:15], a[120:123], v[80:83], a[0:15]
  v_exp_f32 v73, v73
  v_cvt_pk_bf16_f32 v91, v70, v71
  v_exp_f32 v74, v74
  v_exp_f32 v75, v75
  v_cvt_pk_bf16_f32 v92, v72, v73
  v_exp_f32 v76, v76
  v_mfma_f32_32x32x16_bf16 a[0:15], a[124:127], v[84:87], a[0:15]
  v_exp_f32 v77, v77
  v_cvt_pk_bf16_f32 v93, v74, v75
  v_exp_f32 v78, v78
  v_exp_f32 v79, v79
  v_cvt_pk_bf16_f32 v94, v76, v77
  v_cvt_pk_bf16_f32 v95, v78, v79
  v_mfma_f32_32x32x16_bf16 v[64:79], a[112:115], v[16:19], 0
  v_exp_f32 v48, v48
  v_exp_f32 v49, v49
  v_exp_f32 v50, v50
  v_exp_f32 v51, v51
  v_cvt_pk_bf16_f32 v80, v48, v49
  v_exp_f32 v52, v52
  v_mfma_f32_32x32x16_bf16 v[64:79], a[116:119], v[20:23], v[64:79]
  s_add_u32 s50, s24, s73
  v_exp_f32 v53, v53
  v_cvt_pk_bf16_f32 v81, v50, v51
  v_exp_f32 v54, v54
  v_exp_f32 v55, v55
  v_cvt_pk_bf16_f32 v82, v52, v53
  v_exp_f32 v56, v56
  v_mfma_f32_32x32x16_bf16 a[16:31], a[120:123], v[88:91], a[16:31]
  s_addc_u32 s51, s25, 0
  v_exp_f32 v57, v57
  v_cvt_pk_bf16_f32 v83, v54, v55
  v_exp_f32 v58, v58
  v_exp_f32 v59, v59
  v_cvt_pk_bf16_f32 v84, v56, v57
  v_exp_f32 v60, v60
  v_mfma_f32_32x32x16_bf16 a[16:31], a[124:127], v[92:95], a[16:31]
  s_waitcnt vmcnt(16)
  v_exp_f32 v61, v61
  v_cvt_pk_bf16_f32 v85, v58, v59
  v_exp_f32 v62, v62
  v_exp_f32 v63, v63
  v_cvt_pk_bf16_f32 v86, v60, v61
  v_cvt_pk_bf16_f32 v87, v62, v63
  v_mfma_f32_32x32x16_bf16 v[48:63], a[48:51], v[24:27], 0
  global_load_dwordx4 a[112:115], v2, s[50:51] offset:0 sc1
  v_exp_f32 v64, v64
  v_exp_f32 v65, v65
  v_exp_f32 v66, v66
  v_exp_f32 v67, v67
  v_cvt_pk_bf16_f32 v88, v64, v65
  v_exp_f32 v68, v68
  v_mfma_f32_32x32x16_bf16 v[48:63], a[52:55], v[28:31], v[48:63]
  v_exp_f32 v69, v69
  v_cvt_pk_bf16_f32 v89, v66, v67
  v_exp_f32 v70, v70
  v_exp_f32 v71, v71
  v_cvt_pk_bf16_f32 v90, v68, v69
  v_exp_f32 v72, v72
  v_mfma_f32_32x32x16_bf16 a[32:47], a[120:123], v[80:83], a[32:47]
  v_exp_f32 v73, v73
  v_cvt_pk_bf16_f32 v91, v70, v71
  v_exp_f32 v74, v74
  v_exp_f32 v75, v75
  v_cvt_pk_bf16_f32 v92, v72, v73
  v_exp_f32 v76, v76
  v_mfma_f32_32x32x16_bf16 a[32:47], a[124:127], v[84:87], a[32:47]
  v_exp_f32 v77, v77
  v_cvt_pk_bf16_f32 v93, v74, v75
  v_exp_f32 v78, v78
  v_exp_f32 v79, v79
  v_cvt_pk_bf16_f32 v94, v76, v77
  v_cvt_pk_bf16_f32 v95, v78, v79
  v_mfma_f32_32x32x16_bf16 v[64:79], a[48:51], v[32:35], 0
  global_load_dwordx4 a[116:119], v2, s[50:51] offset:1024 sc1
  v_exp_f32 v48, v48
  v_exp_f32 v49, v49
  v_exp_f32 v50, v50
  v_exp_f32 v51, v51
  v_cvt_pk_bf16_f32 v80, v48, v49
  v_exp_f32 v52, v52
  v_mfma_f32_32x32x16_bf16 v[64:79], a[52:55], v[36:39], v[64:79]
  v_exp_f32 v53, v53
  v_cvt_pk_bf16_f32 v81, v50, v51
  v_exp_f32 v54, v54
  v_exp_f32 v55, v55
  v_cvt_pk_bf16_f32 v82, v52, v53
  v_exp_f32 v56, v56
  v_mfma_f32_32x32x16_bf16 v[96:111], a[120:123], v[88:91], v[96:111]
  v_exp_f32 v57, v57
  v_cvt_pk_bf16_f32 v83, v54, v55
  v_exp_f32 v58, v58
  v_exp_f32 v59, v59
  v_cvt_pk_bf16_f32 v84, v56, v57
  v_exp_f32 v60, v60
  v_mfma_f32_32x32x16_bf16 v[96:111], a[124:127], v[92:95], v[96:111]
  v_exp_f32 v61, v61
  v_cvt_pk_bf16_f32 v85, v58, v59
  v_exp_f32 v62, v62
  v_exp_f32 v63, v63
  v_cvt_pk_bf16_f32 v86, v60, v61
  v_cvt_pk_bf16_f32 v87, v62, v63
  v_mfma_f32_32x32x16_bf16 v[48:63], a[48:51], v[40:43], 0
  s_mov_b64 exec, s[82:83]
  global_load_dwordx4 a[120:123], v2, s[50:51] offset:2048 sc1
  global_load_dwordx4 a[124:127], v2, s[50:51] offset:3072 sc1
  s_mov_b64 exec, -1
  v_exp_f32 v64, v64
  v_exp_f32 v65, v65
  v_exp_f32 v66, v66
  v_exp_f32 v67, v67
  v_cvt_pk_bf16_f32 v88, v64, v65
  v_exp_f32 v68, v68
  v_mfma_f32_32x32x16_bf16 v[48:63], a[52:55], v[44:47], v[48:63]
  s_waitcnt vmcnt(18)
  v_exp_f32 v69, v69
  v_cvt_pk_bf16_f32 v89, v66, v67
  v_exp_f32 v70, v70
  v_exp_f32 v71, v71
  v_cvt_pk_bf16_f32 v90, v68, v69
  v_exp_f32 v72, v72
  v_mfma_f32_32x32x16_bf16 a[0:15], a[56:59], v[80:83], a[0:15]
  v_exp_f32 v73, v73
  v_cvt_pk_bf16_f32 v91, v70, v71
  v_exp_f32 v74, v74
  v_exp_f32 v75, v75
  v_cvt_pk_bf16_f32 v92, v72, v73
  v_exp_f32 v76, v76
  v_mfma_f32_32x32x16_bf16 a[0:15], a[60:63], v[84:87], a[0:15]
  v_exp_f32 v77, v77
  v_cvt_pk_bf16_f32 v93, v74, v75
  v_exp_f32 v78, v78
  v_exp_f32 v79, v79
  v_cvt_pk_bf16_f32 v94, v76, v77
  v_cvt_pk_bf16_f32 v95, v78, v79
  v_mfma_f32_32x32x16_bf16 v[64:79], a[48:51], v[16:19], 0
  v_exp_f32 v48, v48
  v_exp_f32 v49, v49
  v_exp_f32 v50, v50
  v_exp_f32 v51, v51
  v_cvt_pk_bf16_f32 v80, v48, v49
  v_exp_f32 v52, v52
  v_mfma_f32_32x32x16_bf16 v[64:79], a[52:55], v[20:23], v[64:79]
  s_add_u32 s48, s24, s74
  v_exp_f32 v53, v53
  v_cvt_pk_bf16_f32 v81, v50, v51
  v_exp_f32 v54, v54
  v_exp_f32 v55, v55
  v_cvt_pk_bf16_f32 v82, v52, v53
  v_exp_f32 v56, v56
  v_mfma_f32_32x32x16_bf16 a[16:31], a[56:59], v[88:91], a[16:31]
  s_addc_u32 s49, s25, 0
  v_exp_f32 v57, v57
  v_cvt_pk_bf16_f32 v83, v54, v55
  v_exp_f32 v58, v58
  v_exp_f32 v59, v59
  v_cvt_pk_bf16_f32 v84, v56, v57
  v_exp_f32 v60, v60
  v_mfma_f32_32x32x16_bf16 a[16:31], a[60:63], v[92:95], a[16:31]
  s_waitcnt vmcnt(16)
  v_exp_f32 v61, v61
  v_cvt_pk_bf16_f32 v85, v58, v59
  v_exp_f32 v62, v62
  v_exp_f32 v63, v63
  v_cvt_pk_bf16_f32 v86, v60, v61
  v_cvt_pk_bf16_f32 v87, v62, v63
  v_mfma_f32_32x32x16_bf16 v[48:63], a[64:67], v[24:27], 0
  global_load_dwordx4 a[48:51], v2, s[48:49] offset:0 sc1
  v_exp_f32 v64, v64
  v_exp_f32 v65, v65
  v_exp_f32 v66, v66
  v_exp_f32 v67, v67
  v_cvt_pk_bf16_f32 v88, v64, v65
  v_exp_f32 v68, v68
  v_mfma_f32_32x32x16_bf16 v[48:63], a[68:71], v[28:31], v[48:63]
  v_exp_f32 v69, v69
  v_cvt_pk_bf16_f32 v89, v66, v67
  v_exp_f32 v70, v70
  v_exp_f32 v71, v71
  v_cvt_pk_bf16_f32 v90, v68, v69
  v_exp_f32 v72, v72
  v_mfma_f32_32x32x16_bf16 a[32:47], a[56:59], v[80:83], a[32:47]
  v_exp_f32 v73, v73
  v_cvt_pk_bf16_f32 v91, v70, v71
  v_exp_f32 v74, v74
  v_exp_f32 v75, v75
  v_cvt_pk_bf16_f32 v92, v72, v73
  v_exp_f32 v76, v76
  v_mfma_f32_32x32x16_bf16 a[32:47], a[60:63], v[84:87], a[32:47]
  v_exp_f32 v77, v77
  v_cvt_pk_bf16_f32 v93, v74, v75
  v_exp_f32 v78, v78
  v_exp_f32 v79, v79
  v_cvt_pk_bf16_f32 v94, v76, v77
  v_cvt_pk_bf16_f32 v95, v78, v79
  v_mfma_f32_32x32x16_bf16 v[64:79], a[64:67], v[32:35], 0
  global_load_dwordx4 a[52:55], v2, s[48:49] offset:1024 sc1
  v_exp_f32 v48, v48
  v_exp_f32 v49, v49
  v_exp_f32 v50, v50
  v_exp_f32 v51, v51
  v_cvt_pk_bf16_f32 v80, v48, v49
  v_exp_f32 v52, v52
  v_mfma_f32_32x32x16_bf16 v[64:79], a[68:71], v[36:39], v[64:79]
  v_exp_f32 v53, v53
  v_cvt_pk_bf16_f32 v81, v50, v51
  v_exp_f32 v54, v54
  v_exp_f32 v55, v55
  v_cvt_pk_bf16_f32 v82, v52, v53
  v_exp_f32 v56, v56
  v_mfma_f32_32x32x16_bf16 v[96:111], a[56:59], v[88:91], v[96:111]
  v_exp_f32 v57, v57
  v_cvt_pk_bf16_f32 v83, v54, v55
  v_exp_f32 v58, v58
  v_exp_f32 v59, v59
  v_cvt_pk_bf16_f32 v84, v56, v57
  v_exp_f32 v60, v60
  v_mfma_f32_32x32x16_bf16 v[96:111], a[60:63], v[92:95], v[96:111]
  v_exp_f32 v61, v61
  v_cvt_pk_bf16_f32 v85, v58, v59
  v_exp_f32 v62, v62
  v_exp_f32 v63, v63
  v_cvt_pk_bf16_f32 v86, v60, v61
  v_cvt_pk_bf16_f32 v87, v62, v63
  v_mfma_f32_32x32x16_bf16 v[48:63], a[64:67], v[40:43], 0
  s_mov_b64 exec, s[82:83]
  global_load_dwordx4 a[56:59], v2, s[48:49] offset:2048 sc1
  global_load_dwordx4 a[60:63], v2, s[48:49] offset:3072 sc1
  s_mov_b64 exec, -1
  v_exp_f32 v64, v64
  v_exp_f32 v65, v65
  v_exp_f32 v66, v66
  v_exp_f32 v67, v67
  v_cvt_pk_bf16_f32 v88, v64, v65
  v_exp_f32 v68, v68
  v_mfma_f32_32x32x16_bf16 v[48:63], a[68:71], v[44:47], v[48:63]
  s_waitcnt vmcnt(18)
  v_exp_f32 v69, v69
  v_cvt_pk_bf16_f32 v89, v66, v67
  v_exp_f32 v70, v70
  v_exp_f32 v71, v71
  v_cvt_pk_bf16_f32 v90, v68, v69
  v_exp_f32 v72, v72
  v_mfma_f32_32x32x16_bf16 a[0:15], a[72:75], v[80:83], a[0:15]
  v_exp_f32 v73, v73
  v_cvt_pk_bf16_f32 v91, v70, v71
  v_exp_f32 v74, v74
  v_exp_f32 v75, v75
  v_cvt_pk_bf16_f32 v92, v72, v73
  v_exp_f32 v76, v76
  v_mfma_f32_32x32x16_bf16 a[0:15], a[76:79], v[84:87], a[0:15]
  v_exp_f32 v77, v77
  v_cvt_pk_bf16_f32 v93, v74, v75
  v_exp_f32 v78, v78
  v_exp_f32 v79, v79
  v_cvt_pk_bf16_f32 v94, v76, v77
  v_cvt_pk_bf16_f32 v95, v78, v79
  v_mfma_f32_32x32x16_bf16 v[64:79], a[64:67], v[16:19], 0
  v_exp_f32 v48, v48
  v_exp_f32 v49, v49
  v_exp_f32 v50, v50
  v_exp_f32 v51, v51
  v_cvt_pk_bf16_f32 v80, v48, v49
  v_exp_f32 v52, v52
  v_mfma_f32_32x32x16_bf16 v[64:79], a[68:71], v[20:23], v[64:79]
  s_add_u32 s50, s24, s75
  v_exp_f32 v53, v53
  v_cvt_pk_bf16_f32 v81, v50, v51
  v_exp_f32 v54, v54
  v_exp_f32 v55, v55
  v_cvt_pk_bf16_f32 v82, v52, v53
  v_exp_f32 v56, v56
  v_mfma_f32_32x32x16_bf16 a[16:31], a[72:75], v[88:91], a[16:31]
  s_addc_u32 s51, s25, 0
  v_exp_f32 v57, v57
  v_cvt_pk_bf16_f32 v83, v54, v55
  v_exp_f32 v58, v58
  v_exp_f32 v59, v59
  v_cvt_pk_bf16_f32 v84, v56, v57
  v_exp_f32 v60, v60
  v_mfma_f32_32x32x16_bf16 a[16:31], a[76:79], v[92:95], a[16:31]
  s_waitcnt vmcnt(15)
  v_exp_f32 v61, v61
  v_cvt_pk_bf16_f32 v85, v58, v59
  v_exp_f32 v62, v62
  v_exp_f32 v63, v63
  v_cvt_pk_bf16_f32 v86, v60, v61
  v_cvt_pk_bf16_f32 v87, v62, v63
  v_mfma_f32_32x32x16_bf16 v[48:63], a[80:83], v[24:27], 0
  global_load_dwordx4 a[64:67], v2, s[50:51] offset:0 sc1
  v_exp_f32 v64, v64
  v_exp_f32 v65, v65
  v_exp_f32 v66, v66
  v_exp_f32 v67, v67
  v_cvt_pk_bf16_f32 v88, v64, v65
  v_exp_f32 v68, v68
  v_mfma_f32_32x32x16_bf16 v[48:63], a[84:87], v[28:31], v[48:63]
  v_exp_f32 v69, v69
  v_cvt_pk_bf16_f32 v89, v66, v67
  v_exp_f32 v70, v70
  v_exp_f32 v71, v71
  v_cvt_pk_bf16_f32 v90, v68, v69
  v_exp_f32 v72, v72
  v_mfma_f32_32x32x16_bf16 a[32:47], a[72:75], v[80:83], a[32:47]
  v_exp_f32 v73, v73
  v_cvt_pk_bf16_f32 v91, v70, v71
  v_exp_f32 v74, v74
  v_exp_f32 v75, v75
  v_cvt_pk_bf16_f32 v92, v72, v73
  v_exp_f32 v76, v76
  v_mfma_f32_32x32x16_bf16 a[32:47], a[76:79], v[84:87], a[32:47]
  v_exp_f32 v77, v77
  v_cvt_pk_bf16_f32 v93, v74, v75
  v_exp_f32 v78, v78
  v_exp_f32 v79, v79
  v_cvt_pk_bf16_f32 v94, v76, v77
  v_cvt_pk_bf16_f32 v95, v78, v79
  v_mfma_f32_32x32x16_bf16 v[64:79], a[80:83], v[32:35], 0
  global_load_dwordx4 a[68:71], v2, s[50:51] offset:1024 sc1
  v_exp_f32 v48, v48
  v_exp_f32 v49, v49
  v_exp_f32 v50, v50
  v_exp_f32 v51, v51
  v_cvt_pk_bf16_f32 v80, v48, v49
  v_exp_f32 v52, v52
  v_mfma_f32_32x32x16_bf16 v[64:79], a[84:87], v[36:39], v[64:79]
  v_exp_f32 v53, v53
  v_cvt_pk_bf16_f32 v81, v50, v51
  v_exp_f32 v54, v54
  v_exp_f32 v55, v55
  v_cvt_pk_bf16_f32 v82, v52, v53
  v_exp_f32 v56, v56
  v_mfma_f32_32x32x16_bf16 v[96:111], a[72:75], v[88:91], v[96:111]
  v_exp_f32 v57, v57
  v_cvt_pk_bf16_f32 v83, v54, v55
  v_exp_f32 v58, v58
  v_exp_f32 v59, v59
  v_cvt_pk_bf16_f32 v84, v56, v57
  v_exp_f32 v60, v60
  v_mfma_f32_32x32x16_bf16 v[96:111], a[76:79], v[92:95], v[96:111]
  v_exp_f32 v61, v61
  v_cvt_pk_bf16_f32 v85, v58, v59
  v_exp_f32 v62, v62
  v_exp_f32 v63, v63
  v_cvt_pk_bf16_f32 v86, v60, v61
  v_cvt_pk_bf16_f32 v87, v62, v63
  v_mfma_f32_32x32x16_bf16 v[48:63], a[80:83], v[40:43], 0
  s_mov_b64 exec, s[82:83]
  global_load_dwordx4 a[72:75], v2, s[50:51] offset:2048 sc1
  global_load_dwordx4 a[76:79], v2, s[50:51] offset:3072 sc1
  s_mov_b64 exec, -1
  v_exp_f32 v64, v64
  v_exp_f32 v65, v65
  v_exp_f32 v66, v66
  v_exp_f32 v67, v67
  v_cvt_pk_bf16_f32 v88, v64, v65
  v_exp_f32 v68, v68
  v_mfma_f32_32x32x16_bf16 v[48:63], a[84:87], v[44:47], v[48:63]
  s_waitcnt vmcnt(16)
  v_exp_f32 v69, v69
  v_cvt_pk_bf16_f32 v89, v66, v67
  v_exp_f32 v70, v70
  v_exp_f32 v71, v71
  v_cvt_pk_bf16_f32 v90, v68, v69
  v_exp_f32 v72, v72
  v_mfma_f32_32x32x16_bf16 a[0:15], a[88:91], v[80:83], a[0:15]
  v_exp_f32 v73, v73
  v_cvt_pk_bf16_f32 v91, v70, v71
  v_exp_f32 v74, v74
  v_exp_f32 v75, v75
  v_cvt_pk_bf16_f32 v92, v72, v73
  v_exp_f32 v76, v76
  v_mfma_f32_32x32x16_bf16 a[0:15], a[92:95], v[84:87], a[0:15]
  v_exp_f32 v77, v77
  v_cvt_pk_bf16_f32 v93, v74, v75
  v_exp_f32 v78, v78
  v_exp_f32 v79, v79
  v_cvt_pk_bf16_f32 v94, v76, v77
  v_cvt_pk_bf16_f32 v95, v78, v79
  v_mfma_f32_32x32x16_bf16 v[64:79], a[80:83], v[16:19], 0
  v_exp_f32 v48, v48
  v_exp_f32 v49, v49
  v_exp_f32 v50, v50
  v_exp_f32 v51, v51
  v_cvt_pk_bf16_f32 v80, v48, v49
  v_exp_f32 v52, v52
  v_mfma_f32_32x32x16_bf16 v[64:79], a[84:87], v[20:23], v[64:79]
  s_add_u32 s48, s24, s76
  v_exp_f32 v53, v53
  v_cvt_pk_bf16_f32 v81, v50, v51
  v_exp_f32 v54, v54
  v_exp_f32 v55, v55
  v_cvt_pk_bf16_f32 v82, v52, v53
  v_exp_f32 v56, v56
  v_mfma_f32_32x32x16_bf16 a[16:31], a[88:91], v[88:91], a[16:31]
  s_addc_u32 s49, s25, 0
  v_exp_f32 v57, v57
  v_cvt_pk_bf16_f32 v83, v54, v55
  v_exp_f32 v58, v58
  v_exp_f32 v59, v59
  v_cvt_pk_bf16_f32 v84, v56, v57
  v_exp_f32 v60, v60
  v_mfma_f32_32x32x16_bf16 a[16:31], a[92:95], v[92:95], a[16:31]
  s_waitcnt vmcnt(14)
  v_exp_f32 v61, v61
  v_cvt_pk_bf16_f32 v85, v58, v59
  v_exp_f32 v62, v62
  v_exp_f32 v63, v63
  v_cvt_pk_bf16_f32 v86, v60, v61
  v_cvt_pk_bf16_f32 v87, v62, v63
  v_mfma_f32_32x32x16_bf16 v[48:63], a[96:99], v[24:27], 0
  global_load_dwordx4 a[80:83], v2, s[48:49] offset:0 sc1
  v_exp_f32 v64, v64
  v_exp_f32 v65, v65
  v_exp_f32 v66, v66
  v_exp_f32 v67, v67
  v_cvt_pk_bf16_f32 v88, v64, v65
  v_exp_f32 v68, v68
  v_mfma_f32_32x32x16_bf16 v[48:63], a[100:103], v[28:31], v[48:63]
  v_exp_f32 v69, v69
  v_cvt_pk_bf16_f32 v89, v66, v67
  v_exp_f32 v70, v70
  v_exp_f32 v71, v71
  v_cvt_pk_bf16_f32 v90, v68, v69
  v_exp_f32 v72, v72
  v_mfma_f32_32x32x16_bf16 a[32:47], a[88:91], v[80:83], a[32:47]
  v_exp_f32 v73, v73
  v_cvt_pk_bf16_f32 v91, v70, v71
  v_exp_f32 v74, v74
  v_exp_f32 v75, v75
  v_cvt_pk_bf16_f32 v92, v72, v73
  v_exp_f32 v76, v76
  v_mfma_f32_32x32x16_bf16 a[32:47], a[92:95], v[84:87], a[32:47]
  v_exp_f32 v77, v77
  v_cvt_pk_bf16_f32 v93, v74, v75
  v_exp_f32 v78, v78
  v_exp_f32 v79, v79
  v_cvt_pk_bf16_f32 v94, v76, v77
  v_cvt_pk_bf16_f32 v95, v78, v79
  v_mfma_f32_32x32x16_bf16 v[64:79], a[96:99], v[32:35], 0
  global_load_dwordx4 a[84:87], v2, s[48:49] offset:1024 sc1
  v_exp_f32 v48, v48
  v_exp_f32 v49, v49
  v_exp_f32 v50, v50
  v_exp_f32 v51, v51
  v_cvt_pk_bf16_f32 v80, v48, v49
  v_exp_f32 v52, v52
  v_mfma_f32_32x32x16_bf16 v[64:79], a[100:103], v[36:39], v[64:79]
  v_exp_f32 v53, v53
  v_cvt_pk_bf16_f32 v81, v50, v51
  v_exp_f32 v54, v54
  v_exp_f32 v55, v55
  v_cvt_pk_bf16_f32 v82, v52, v53
  v_exp_f32 v56, v56
  v_mfma_f32_32x32x16_bf16 v[96:111], a[88:91], v[88:91], v[96:111]
  v_exp_f32 v57, v57
  v_cvt_pk_bf16_f32 v83, v54, v55
  v_exp_f32 v58, v58
  v_exp_f32 v59, v59
  v_cvt_pk_bf16_f32 v84, v56, v57
  v_exp_f32 v60, v60
  v_mfma_f32_32x32x16_bf16 v[96:111], a[92:95], v[92:95], v[96:111]
  v_exp_f32 v61, v61
  v_cvt_pk_bf16_f32 v85, v58, v59
  v_exp_f32 v62, v62
  v_exp_f32 v63, v63
  v_cvt_pk_bf16_f32 v86, v60, v61
  v_cvt_pk_bf16_f32 v87, v62, v63
  v_mfma_f32_32x32x16_bf16 v[48:63], a[96:99], v[40:43], 0
  s_mov_b64 exec, s[82:83]
  global_load_dwordx4 a[88:91], v2, s[48:49] offset:2048 sc1
  global_load_dwordx4 a[92:95], v2, s[48:49] offset:3072 sc1
  s_mov_b64 exec, -1
  v_exp_f32 v64, v64
  v_exp_f32 v65, v65
  v_exp_f32 v66, v66
  v_exp_f32 v67, v67
  v_cvt_pk_bf16_f32 v88, v64, v65
  v_exp_f32 v68, v68
  v_mfma_f32_32x32x16_bf16 v[48:63], a[100:103], v[44:47], v[48:63]
  s_waitcnt vmcnt(16)
  v_exp_f32 v69, v69
  v_cvt_pk_bf16_f32 v89, v66, v67
  v_exp_f32 v70, v70
  v_exp_f32 v71, v71
  v_cvt_pk_bf16_f32 v90, v68, v69
  v_exp_f32 v72, v72
  v_mfma_f32_32x32x16_bf16 a[0:15], a[104:107], v[80:83], a[0:15]
  v_exp_f32 v73, v73
  v_cvt_pk_bf16_f32 v91, v70, v71
  v_exp_f32 v74, v74
  v_exp_f32 v75, v75
  v_cvt_pk_bf16_f32 v92, v72, v73
  v_exp_f32 v76, v76
  v_mfma_f32_32x32x16_bf16 a[0:15], a[108:111], v[84:87], a[0:15]
  v_exp_f32 v77, v77
  v_cvt_pk_bf16_f32 v93, v74, v75
  v_exp_f32 v78, v78
  v_exp_f32 v79, v79
  v_cvt_pk_bf16_f32 v94, v76, v77
  v_cvt_pk_bf16_f32 v95, v78, v79
  v_mfma_f32_32x32x16_bf16 v[64:79], a[96:99], v[16:19], 0
  v_exp_f32 v48, v48
  v_exp_f32 v49, v49
  v_exp_f32 v50, v50
  v_exp_f32 v51, v51
  v_cvt_pk_bf16_f32 v80, v48, v49
  v_exp_f32 v52, v52
  v_mfma_f32_32x32x16_bf16 v[64:79], a[100:103], v[20:23], v[64:79]
  s_add_u32 s50, s24, s77
  v_exp_f32 v53, v53
  v_cvt_pk_bf16_f32 v81, v50, v51
  v_exp_f32 v54, v54
  v_exp_f32 v55, v55
  v_cvt_pk_bf16_f32 v82, v52, v53
  v_exp_f32 v56, v56
  v_mfma_f32_32x32x16_bf16 a[16:31], a[104:107], v[88:91], a[16:31]
  s_addc_u32 s51, s25, 0
  v_exp_f32 v57, v57
  v_cvt_pk_bf16_f32 v83, v54, v55
  v_exp_f32 v58, v58
  v_exp_f32 v59, v59
  v_cvt_pk_bf16_f32 v84, v56, v57
  v_exp_f32 v60, v60
  v_mfma_f32_32x32x16_bf16 a[16:31], a[108:111], v[92:95], a[16:31]
  s_waitcnt vmcnt(14)
  v_exp_f32 v61, v61
  v_cvt_pk_bf16_f32 v85, v58, v59
  v_exp_f32 v62, v62
  v_exp_f32 v63, v63
  v_cvt_pk_bf16_f32 v86, v60, v61
  v_cvt_pk_bf16_f32 v87, v62, v63
  v_mfma_f32_32x32x16_bf16 v[48:63], a[112:115], v[24:27], 0
  global_load_dwordx4 a[96:99], v2, s[50:51] offset:0 sc1
  v_exp_f32 v64, v64
  v_exp_f32 v65, v65
  v_exp_f32 v66, v66
  v_exp_f32 v67, v67
  v_cvt_pk_bf16_f32 v88, v64, v65
  v_exp_f32 v68, v68
  v_mfma_f32_32x32x16_bf16 v[48:63], a[116:119], v[28:31], v[48:63]
  v_exp_f32 v69, v69
  v_cvt_pk_bf16_f32 v89, v66, v67
  v_exp_f32 v70, v70
  v_exp_f32 v71, v71
  v_cvt_pk_bf16_f32 v90, v68, v69
  v_exp_f32 v72, v72
  v_mfma_f32_32x32x16_bf16 a[32:47], a[104:107], v[80:83], a[32:47]
  v_exp_f32 v73, v73
  v_cvt_pk_bf16_f32 v91, v70, v71
  v_exp_f32 v74, v74
  v_exp_f32 v75, v75
  v_cvt_pk_bf16_f32 v92, v72, v73
  v_exp_f32 v76, v76
  v_mfma_f32_32x32x16_bf16 a[32:47], a[108:111], v[84:87], a[32:47]
  v_exp_f32 v77, v77
  v_cvt_pk_bf16_f32 v93, v74, v75
  v_exp_f32 v78, v78
  v_exp_f32 v79, v79
  v_cvt_pk_bf16_f32 v94, v76, v77
  v_cvt_pk_bf16_f32 v95, v78, v79
  v_mfma_f32_32x32x16_bf16 v[64:79], a[112:115], v[32:35], 0
  global_load_dwordx4 a[100:103], v2, s[50:51] offset:1024 sc1
  v_exp_f32 v48, v48
  v_exp_f32 v49, v49
  v_exp_f32 v50, v50
  v_exp_f32 v51, v51
  v_cvt_pk_bf16_f32 v80, v48, v49
  v_exp_f32 v52, v52
  v_mfma_f32_32x32x16_bf16 v[64:79], a[116:119], v[36:39], v[64:79]
  v_exp_f32 v53, v53
  v_cvt_pk_bf16_f32 v81, v50, v51
  v_exp_f32 v54, v54
  v_exp_f32 v55, v55
  v_cvt_pk_bf16_f32 v82, v52, v53
  v_exp_f32 v56, v56
  v_mfma_f32_32x32x16_bf16 v[96:111], a[104:107], v[88:91], v[96:111]
  v_exp_f32 v57, v57
  v_cvt_pk_bf16_f32 v83, v54, v55
  v_exp_f32 v58, v58
  v_exp_f32 v59, v59
  v_cvt_pk_bf16_f32 v84, v56, v57
  v_exp_f32 v60, v60
  v_mfma_f32_32x32x16_bf16 v[96:111], a[108:111], v[92:95], v[96:111]
  v_exp_f32 v61, v61
  v_cvt_pk_bf16_f32 v85, v58, v59
  v_exp_f32 v62, v62
  v_exp_f32 v63, v63
  v_cvt_pk_bf16_f32 v86, v60, v61
  v_cvt_pk_bf16_f32 v87, v62, v63
  v_mfma_f32_32x32x16_bf16 v[48:63], a[112:115], v[40:43], 0
  s_mov_b64 exec, s[82:83]
  global_load_dwordx4 a[104:107], v2, s[50:51] offset:2048 sc1
  global_load_dwordx4 a[108:111], v2, s[50:51] offset:3072 sc1
  s_mov_b64 exec, -1
  v_exp_f32 v64, v64
  v_exp_f32 v65, v65
  v_exp_f32 v66, v66
  v_exp_f32 v67, v67
  v_cvt_pk_bf16_f32 v88, v64, v65
  v_exp_f32 v68, v68
  v_mfma_f32_32x32x16_bf16 v[48:63], a[116:119], v[44:47], v[48:63]
  s_waitcnt vmcnt(16)
  v_exp_f32 v69, v69
  v_cvt_pk_bf16_f32 v89, v66, v67
  v_exp_f32 v70, v70
  v_exp_f32 v71, v71
  v_cvt_pk_bf16_f32 v90, v68, v69
  v_exp_f32 v72, v72
  v_mfma_f32_32x32x16_bf16 a[0:15], a[120:123], v[80:83], a[0:15]
  v_exp_f32 v73, v73
  v_cvt_pk_bf16_f32 v91, v70, v71
  v_exp_f32 v74, v74
  v_exp_f32 v75, v75
  v_cvt_pk_bf16_f32 v92, v72, v73
  v_exp_f32 v76, v76
  v_mfma_f32_32x32x16_bf16 a[0:15], a[124:127], v[84:87], a[0:15]
  v_exp_f32 v77, v77
  v_cvt_pk_bf16_f32 v93, v74, v75
  v_exp_f32 v78, v78
  v_exp_f32 v79, v79
  v_cvt_pk_bf16_f32 v94, v76, v77
  v_cvt_pk_bf16_f32 v95, v78, v79
  v_mfma_f32_32x32x16_bf16 v[64:79], a[112:115], v[16:19], 0
  v_exp_f32 v48, v48
  v_exp_f32 v49, v49
  v_exp_f32 v50, v50
  v_exp_f32 v51, v51
  v_cvt_pk_bf16_f32 v80, v48, v49
  v_exp_f32 v52, v52
  v_mfma_f32_32x32x16_bf16 v[64:79], a[116:119], v[20:23], v[64:79]
  s_add_u32 s48, s24, s78
  v_exp_f32 v53, v53
  v_cvt_pk_bf16_f32 v81, v50, v51
  v_exp_f32 v54, v54
  v_exp_f32 v55, v55
  v_cvt_pk_bf16_f32 v82, v52, v53
  v_exp_f32 v56, v56
  v_mfma_f32_32x32x16_bf16 a[16:31], a[120:123], v[88:91], a[16:31]
  s_addc_u32 s49, s25, 0
  v_exp_f32 v57, v57
  v_cvt_pk_bf16_f32 v83, v54, v55
  v_exp_f32 v58, v58
  v_exp_f32 v59, v59
  v_cvt_pk_bf16_f32 v84, v56, v57
  v_exp_f32 v60, v60
  v_mfma_f32_32x32x16_bf16 a[16:31], a[124:127], v[92:95], a[16:31]
  s_waitcnt vmcnt(14)
  v_exp_f32 v61, v61
  v_cvt_pk_bf16_f32 v85, v58, v59
  v_exp_f32 v62, v62
  v_exp_f32 v63, v63
  v_cvt_pk_bf16_f32 v86, v60, v61
  v_cvt_pk_bf16_f32 v87, v62, v63
  v_mfma_f32_32x32x16_bf16 v[48:63], a[48:51], v[24:27], 0
  global_load_dwordx4 a[112:115], v2, s[48:49] offset:0 sc1
  v_exp_f32 v64, v64
  v_exp_f32 v65, v65
  v_exp_f32 v66, v66
  v_exp_f32 v67, v67
  v_cvt_pk_bf16_f32 v88, v64, v65
  v_exp_f32 v68, v68
  v_mfma_f32_32x32x16_bf16 v[48:63], a[52:55], v[28:31], v[48:63]
  v_exp_f32 v69, v69
  v_cvt_pk_bf16_f32 v89, v66, v67
  v_exp_f32 v70, v70
  v_exp_f32 v71, v71
  v_cvt_pk_bf16_f32 v90, v68, v69
  v_exp_f32 v72, v72
  v_mfma_f32_32x32x16_bf16 a[32:47], a[120:123], v[80:83], a[32:47]
  v_exp_f32 v73, v73
  v_cvt_pk_bf16_f32 v91, v70, v71
  v_exp_f32 v74, v74
  v_exp_f32 v75, v75
  v_cvt_pk_bf16_f32 v92, v72, v73
  v_exp_f32 v76, v76
  v_mfma_f32_32x32x16_bf16 a[32:47], a[124:127], v[84:87], a[32:47]
  v_exp_f32 v77, v77
  v_cvt_pk_bf16_f32 v93, v74, v75
  v_exp_f32 v78, v78
  v_exp_f32 v79, v79
  v_cvt_pk_bf16_f32 v94, v76, v77
  v_cvt_pk_bf16_f32 v95, v78, v79
  v_mfma_f32_32x32x16_bf16 v[64:79], a[48:51], v[32:35], 0
  global_load_dwordx4 a[116:119], v2, s[48:49] offset:1024 sc1
  v_exp_f32 v48, v48
  v_exp_f32 v49, v49
  v_exp_f32 v50, v50
  v_exp_f32 v51, v51
  v_cvt_pk_bf16_f32 v80, v48, v49
  v_exp_f32 v52, v52
  v_mfma_f32_32x32x16_bf16 v[64:79], a[52:55], v[36:39], v[64:79]
  v_exp_f32 v53, v53
  v_cvt_pk_bf16_f32 v81, v50, v51
  v_exp_f32 v54, v54
  v_exp_f32 v55, v55
  v_cvt_pk_bf16_f32 v82, v52, v53
  v_exp_f32 v56, v56
  v_mfma_f32_32x32x16_bf16 v[96:111], a[120:123], v[88:91], v[96:111]
  v_exp_f32 v57, v57
  v_cvt_pk_bf16_f32 v83, v54, v55
  v_exp_f32 v58, v58
  v_exp_f32 v59, v59
  v_cvt_pk_bf16_f32 v84, v56, v57
  v_exp_f32 v60, v60
  v_mfma_f32_32x32x16_bf16 v[96:111], a[124:127], v[92:95], v[96:111]
  v_exp_f32 v61, v61
  v_cvt_pk_bf16_f32 v85, v58, v59
  v_exp_f32 v62, v62
  v_exp_f32 v63, v63
  v_cvt_pk_bf16_f32 v86, v60, v61
  v_cvt_pk_bf16_f32 v87, v62, v63
  v_mfma_f32_32x32x16_bf16 v[48:63], a[48:51], v[40:43], 0
  s_mov_b64 exec, s[82:83]
  global_load_dwordx4 a[120:123], v2, s[48:49] offset:2048 sc1
  global_load_dwordx4 a[124:127], v2, s[48:49] offset:3072 sc1
  s_mov_b64 exec, -1
  v_exp_f32 v64, v64
  v_exp_f32 v65, v65
  v_exp_f32 v66, v66
  v_exp_f32 v67, v67
  v_cvt_pk_bf16_f32 v88, v64, v65
  v_exp_f32 v68, v68
  v_mfma_f32_32x32x16_bf16 v[48:63], a[52:55], v[44:47], v[48:63]
  s_waitcnt vmcnt(16)
  v_exp_f32 v69, v69
  v_cvt_pk_bf16_f32 v89, v66, v67
  v_exp_f32 v70, v70
  v_exp_f32 v71, v71
  v_cvt_pk_bf16_f32 v90, v68, v69
  v_exp_f32 v72, v72
  v_mfma_f32_32x32x16_bf16 a[0:15], a[56:59], v[80:83], a[0:15]
  v_exp_f32 v73, v73
  v_cvt_pk_bf16_f32 v91, v70, v71
  v_exp_f32 v74, v74
  v_exp_f32 v75, v75
  v_cvt_pk_bf16_f32 v92, v72, v73
  v_exp_f32 v76, v76
  v_mfma_f32_32x32x16_bf16 a[0:15], a[60:63], v[84:87], a[0:15]
  v_exp_f32 v77, v77
  v_cvt_pk_bf16_f32 v93, v74, v75
  v_exp_f32 v78, v78
  v_exp_f32 v79, v79
  v_cvt_pk_bf16_f32 v94, v76, v77
  v_cvt_pk_bf16_f32 v95, v78, v79
  v_mfma_f32_32x32x16_bf16 v[64:79], a[48:51], v[16:19], 0
  v_exp_f32 v48, v48
  v_exp_f32 v49, v49
  v_exp_f32 v50, v50
  v_exp_f32 v51, v51
  v_cvt_pk_bf16_f32 v80, v48, v49
  v_exp_f32 v52, v52
  v_mfma_f32_32x32x16_bf16 v[64:79], a[52:55], v[20:23], v[64:79]
  s_add_u32 s50, s24, s79
  v_exp_f32 v53, v53
  v_cvt_pk_bf16_f32 v81, v50, v51
  v_exp_f32 v54, v54
  v_exp_f32 v55, v55
  v_cvt_pk_bf16_f32 v82, v52, v53
  v_exp_f32 v56, v56
  v_mfma_f32_32x32x16_bf16 a[16:31], a[56:59], v[88:91], a[16:31]
  s_addc_u32 s51, s25, 0
  v_exp_f32 v57, v57
  v_cvt_pk_bf16_f32 v83, v54, v55
  v_exp_f32 v58, v58
  v_exp_f32 v59, v59
  v_cvt_pk_bf16_f32 v84, v56, v57
  v_exp_f32 v60, v60
  v_mfma_f32_32x32x16_bf16 a[16:31], a[60:63], v[92:95], a[16:31]
  s_waitcnt vmcnt(14)
  v_exp_f32 v61, v61
  v_cvt_pk_bf16_f32 v85, v58, v59
  v_exp_f32 v62, v62
  v_exp_f32 v63, v63
  v_cvt_pk_bf16_f32 v86, v60, v61
  v_cvt_pk_bf16_f32 v87, v62, v63
  v_mfma_f32_32x32x16_bf16 v[48:63], a[64:67], v[24:27], 0
  global_load_dwordx4 a[48:51], v2, s[50:51] offset:0 sc1
  v_exp_f32 v64, v64
  v_exp_f32 v65, v65
  v_exp_f32 v66, v66
  v_exp_f32 v67, v67
  v_cvt_pk_bf16_f32 v88, v64, v65
  v_exp_f32 v68, v68
  v_mfma_f32_32x32x16_bf16 v[48:63], a[68:71], v[28:31], v[48:63]
  v_exp_f32 v69, v69
  v_cvt_pk_bf16_f32 v89, v66, v67
  v_exp_f32 v70, v70
  v_exp_f32 v71, v71
  v_cvt_pk_bf16_f32 v90, v68, v69
  v_exp_f32 v72, v72
  v_mfma_f32_32x32x16_bf16 a[32:47], a[56:59], v[80:83], a[32:47]
  v_exp_f32 v73, v73
  v_cvt_pk_bf16_f32 v91, v70, v71
  v_exp_f32 v74, v74
  v_exp_f32 v75, v75
  v_cvt_pk_bf16_f32 v92, v72, v73
  v_exp_f32 v76, v76
  v_mfma_f32_32x32x16_bf16 a[32:47], a[60:63], v[84:87], a[32:47]
  v_exp_f32 v77, v77
  v_cvt_pk_bf16_f32 v93, v74, v75
  v_exp_f32 v78, v78
  v_exp_f32 v79, v79
  v_cvt_pk_bf16_f32 v94, v76, v77
  v_cvt_pk_bf16_f32 v95, v78, v79
  v_mfma_f32_32x32x16_bf16 v[64:79], a[64:67], v[32:35], 0
  global_load_dwordx4 a[52:55], v2, s[50:51] offset:1024 sc1
  v_exp_f32 v48, v48
  v_exp_f32 v49, v49
  v_exp_f32 v50, v50
  v_exp_f32 v51, v51
  v_cvt_pk_bf16_f32 v80, v48, v49
  v_exp_f32 v52, v52
  v_mfma_f32_32x32x16_bf16 v[64:79], a[68:71], v[36:39], v[64:79]
  v_exp_f32 v53, v53
  v_cvt_pk_bf16_f32 v81, v50, v51
  v_exp_f32 v54, v54
  v_exp_f32 v55, v55
  v_cvt_pk_bf16_f32 v82, v52, v53
  v_exp_f32 v56, v56
  v_mfma_f32_32x32x16_bf16 v[96:111], a[56:59], v[88:91], v[96:111]
  v_exp_f32 v57, v57
  v_cvt_pk_bf16_f32 v83, v54, v55
  v_exp_f32 v58, v58
  v_exp_f32 v59, v59
  v_cvt_pk_bf16_f32 v84, v56, v57
  v_exp_f32 v60, v60
  v_mfma_f32_32x32x16_bf16 v[96:111], a[60:63], v[92:95], v[96:111]
  v_exp_f32 v61, v61
  v_cvt_pk_bf16_f32 v85, v58, v59
  v_exp_f32 v62, v62
  v_exp_f32 v63, v63
  v_cvt_pk_bf16_f32 v86, v60, v61
  v_cvt_pk_bf16_f32 v87, v62, v63
  v_mfma_f32_32x32x16_bf16 v[48:63], a[64:67], v[40:43], 0
  s_mov_b64 exec, s[82:83]
  global_load_dwordx4 a[56:59], v2, s[50:51] offset:2048 sc1
  global_load_dwordx4 a[60:63], v2, s[50:51] offset:3072 sc1
  s_mov_b64 exec, -1
  v_exp_f32 v64, v64
  v_exp_f32 v65, v65
  v_exp_f32 v66, v66
  v_exp_f32 v67, v67
  v_cvt_pk_bf16_f32 v88, v64, v65
  v_exp_f32 v68, v68
  v_mfma_f32_32x32x16_bf16 v[48:63], a[68:71], v[44:47], v[48:63]
  s_waitcnt vmcnt(16)
  v_exp_f32 v69, v69
  v_cvt_pk_bf16_f32 v89, v66, v67
  v_exp_f32 v70, v70
  v_exp_f32 v71, v71
  v_cvt_pk_bf16_f32 v90, v68, v69
  v_exp_f32 v72, v72
  v_mfma_f32_32x32x16_bf16 a[0:15], a[72:75], v[80:83], a[0:15]
  v_exp_f32 v73, v73
  v_cvt_pk_bf16_f32 v91, v70, v71
  v_exp_f32 v74, v74
  v_exp_f32 v75, v75
  v_cvt_pk_bf16_f32 v92, v72, v73
  v_exp_f32 v76, v76
  v_mfma_f32_32x32x16_bf16 a[0:15], a[76:79], v[84:87], a[0:15]
  s_waitcnt vmcnt(14)
  v_exp_f32 v77, v77
  v_cvt_pk_bf16_f32 v93, v74, v75
  v_exp_f32 v78, v78
  v_exp_f32 v79, v79
  v_cvt_pk_bf16_f32 v94, v76, v77
  v_cvt_pk_bf16_f32 v95, v78, v79
  v_mfma_f32_32x32x16_bf16 v[64:79], a[80:83], v[24:27], 0
  v_exp_f32 v48, v48
  v_exp_f32 v49, v49
  v_exp_f32 v50, v50
  v_exp_f32 v51, v51
  v_cvt_pk_bf16_f32 v80, v48, v49
  v_exp_f32 v52, v52
  v_mfma_f32_32x32x16_bf16 v[64:79], a[84:87], v[28:31], v[64:79]
  v_exp_f32 v53, v53
  v_cvt_pk_bf16_f32 v81, v50, v51
  v_exp_f32 v54, v54
  v_exp_f32 v55, v55
  v_cvt_pk_bf16_f32 v82, v52, v53
  v_exp_f32 v56, v56
  v_mfma_f32_32x32x16_bf16 a[16:31], a[72:75], v[88:91], a[16:31]
  v_exp_f32 v57, v57
  v_cvt_pk_bf16_f32 v83, v54, v55
  v_exp_f32 v58, v58
  v_exp_f32 v59, v59
  v_cvt_pk_bf16_f32 v84, v56, v57
  v_exp_f32 v60, v60
  v_mfma_f32_32x32x16_bf16 a[16:31], a[76:79], v[92:95], a[16:31]
  v_exp_f32 v61, v61
  v_cvt_pk_bf16_f32 v85, v58, v59
  v_exp_f32 v62, v62
  v_exp_f32 v63, v63
  v_cvt_pk_bf16_f32 v86, v60, v61
  v_cvt_pk_bf16_f32 v87, v62, v63
  v_mfma_f32_32x32x16_bf16 v[48:63], a[80:83], v[32:35], 0
  v_exp_f32 v64, v64
  v_exp_f32 v65, v65
  v_exp_f32 v66, v66
  v_exp_f32 v67, v67
  v_cvt_pk_bf16_f32 v88, v64, v65
  v_exp_f32 v68, v68
  v_mfma_f32_32x32x16_bf16 v[48:63], a[84:87], v[36:39], v[48:63]
  v_exp_f32 v69, v69
  v_cvt_pk_bf16_f32 v89, v66, v67
  v_exp_f32 v70, v70
  v_exp_f32 v71, v71
  v_cvt_pk_bf16_f32 v90, v68, v69
  v_exp_f32 v72, v72
  v_mfma_f32_32x32x16_bf16 a[32:47], a[72:75], v[80:83], a[32:47]
  v_exp_f32 v73, v73
  v_cvt_pk_bf16_f32 v91, v70, v71
  v_exp_f32 v74, v74
  v_exp_f32 v75, v75
  v_cvt_pk_bf16_f32 v92, v72, v73
  v_exp_f32 v76, v76
  v_mfma_f32_32x32x16_bf16 a[32:47], a[76:79], v[84:87], a[32:47]
  v_exp_f32 v77, v77
  v_cvt_pk_bf16_f32 v93, v74, v75
  v_exp_f32 v78, v78
  v_exp_f32 v79, v79
  v_cvt_pk_bf16_f32 v94, v76, v77
  v_cvt_pk_bf16_f32 v95, v78, v79
  v_mfma_f32_32x32x16_bf16 v[64:79], a[80:83], v[40:43], 0
  v_exp_f32 v48, v48
  v_exp_f32 v49, v49
  v_exp_f32 v50, v50
  v_exp_f32 v51, v51
  v_cvt_pk_bf16_f32 v80, v48, v49
  v_exp_f32 v52, v52
  v_mfma_f32_32x32x16_bf16 v[64:79], a[84:87], v[44:47], v[64:79]
  s_waitcnt vmcnt(12)
  v_exp_f32 v53, v53
  v_cvt_pk_bf16_f32 v81, v50, v51
  v_exp_f32 v54, v54
  v_exp_f32 v55, v55
  v_cvt_pk_bf16_f32 v82, v52, v53
  v_exp_f32 v56, v56
  v_mfma_f32_32x32x16_bf16 a[0:15], a[88:91], v[88:91], a[0:15]
  v_exp_f32 v57, v57
  v_cvt_pk_bf16_f32 v83, v54, v55
  v_exp_f32 v58, v58
  v_exp_f32 v59, v59
  v_cvt_pk_bf16_f32 v84, v56, v57
  v_exp_f32 v60, v60
  v_mfma_f32_32x32x16_bf16 a[0:15], a[92:95], v[92:95], a[0:15]
  s_waitcnt vmcnt(10)
  v_exp_f32 v61, v61
  v_cvt_pk_bf16_f32 v85, v58, v59
  v_exp_f32 v62, v62
  v_exp_f32 v63, v63
  v_cvt_pk_bf16_f32 v86, v60, v61
  v_cvt_pk_bf16_f32 v87, v62, v63
  v_mfma_f32_32x32x16_bf16 v[48:63], a[96:99], v[24:27], 0
  v_exp_f32 v64, v64
  v_exp_f32 v65, v65
  v_exp_f32 v66, v66
  v_exp_f32 v67, v67
  v_cvt_pk_bf16_f32 v88, v64, v65
  v_exp_f32 v68, v68
  v_mfma_f32_32x32x16_bf16 v[48:63], a[100:103], v[28:31], v[48:63]
  v_exp_f32 v69, v69
  v_cvt_pk_bf16_f32 v89, v66, v67
  v_exp_f32 v70, v70
  v_exp_f32 v71, v71
  v_cvt_pk_bf16_f32 v90, v68, v69
  v_exp_f32 v72, v72
  v_mfma_f32_32x32x16_bf16 a[16:31], a[88:91], v[80:83], a[16:31]
  v_exp_f32 v73, v73
  v_cvt_pk_bf16_f32 v91, v70, v71
  v_exp_f32 v74, v74
  v_exp_f32 v75, v75
  v_cvt_pk_bf16_f32 v92, v72, v73
  v_exp_f32 v76, v76
  v_mfma_f32_32x32x16_bf16 a[16:31], a[92:95], v[84:87], a[16:31]
  v_exp_f32 v77, v77
  v_cvt_pk_bf16_f32 v93, v74, v75
  v_exp_f32 v78, v78
  v_exp_f32 v79, v79
  v_cvt_pk_bf16_f32 v94, v76, v77
  v_cvt_pk_bf16_f32 v95, v78, v79
  v_mfma_f32_32x32x16_bf16 v[64:79], a[96:99], v[32:35], 0
  v_exp_f32 v48, v48
  v_exp_f32 v49, v49
  v_exp_f32 v50, v50
  v_exp_f32 v51, v51
  v_cvt_pk_bf16_f32 v80, v48, v49
  v_exp_f32 v52, v52
  v_mfma_f32_32x32x16_bf16 v[64:79], a[100:103], v[36:39], v[64:79]
  v_exp_f32 v53, v53
  v_cvt_pk_bf16_f32 v81, v50, v51
  v_exp_f32 v54, v54
  v_exp_f32 v55, v55
  v_cvt_pk_bf16_f32 v82, v52, v53
  v_exp_f32 v56, v56
  v_mfma_f32_32x32x16_bf16 a[32:47], a[88:91], v[88:91], a[32:47]
  v_exp_f32 v57, v57
  v_cvt_pk_bf16_f32 v83, v54, v55
  v_exp_f32 v58, v58
  v_exp_f32 v59, v59
  v_cvt_pk_bf16_f32 v84, v56, v57
  v_exp_f32 v60, v60
  v_mfma_f32_32x32x16_bf16 a[32:47], a[92:95], v[92:95], a[32:47]
  v_exp_f32 v61, v61
  v_cvt_pk_bf16_f32 v85, v58, v59
  v_exp_f32 v62, v62
  v_exp_f32 v63, v63
  v_cvt_pk_bf16_f32 v86, v60, v61
  v_cvt_pk_bf16_f32 v87, v62, v63
  v_mfma_f32_32x32x16_bf16 v[48:63], a[96:99], v[40:43], 0
  v_exp_f32 v64, v64
  v_exp_f32 v65, v65
  v_exp_f32 v66, v66
  v_exp_f32 v67, v67
  v_cvt_pk_bf16_f32 v88, v64, v65
  v_exp_f32 v68, v68
  v_mfma_f32_32x32x16_bf16 v[48:63], a[100:103], v[44:47], v[48:63]
  s_waitcnt vmcnt(8)
  v_exp_f32 v69, v69
  v_cvt_pk_bf16_f32 v89, v66, v67
  v_exp_f32 v70, v70
  v_exp_f32 v71, v71
  v_cvt_pk_bf16_f32 v90, v68, v69
  v_exp_f32 v72, v72
  v_mfma_f32_32x32x16_bf16 a[0:15], a[104:107], v[80:83], a[0:15]
  v_exp_f32 v73, v73
  v_cvt_pk_bf16_f32 v91, v70, v71
  v_exp_f32 v74, v74
  v_exp_f32 v75, v75
  v_cvt_pk_bf16_f32 v92, v72, v73
  v_exp_f32 v76, v76
  v_mfma_f32_32x32x16_bf16 a[0:15], a[108:111], v[84:87], a[0:15]
  s_waitcnt vmcnt(6)
  v_exp_f32 v77, v77
  v_cvt_pk_bf16_f32 v93, v74, v75
  v_exp_f32 v78, v78
  v_exp_f32 v79, v79
  v_cvt_pk_bf16_f32 v94, v76, v77
  v_cvt_pk_bf16_f32 v95, v78, v79
  v_mfma_f32_32x32x16_bf16 v[64:79], a[112:115], v[24:27], 0
  v_exp_f32 v48, v48
  v_exp_f32 v49, v49
  v_exp_f32 v50, v50
  v_exp_f32 v51, v51
  v_cvt_pk_bf16_f32 v80, v48, v49
  v_exp_f32 v52, v52
  v_mfma_f32_32x32x16_bf16 v[64:79], a[116:119], v[28:31], v[64:79]
  v_exp_f32 v53, v53
  v_cvt_pk_bf16_f32 v81, v50, v51
  v_exp_f32 v54, v54
  v_exp_f32 v55, v55
  v_cvt_pk_bf16_f32 v82, v52, v53
  v_exp_f32 v56, v56
  v_mfma_f32_32x32x16_bf16 a[16:31], a[104:107], v[88:91], a[16:31]
  v_exp_f32 v57, v57
  v_cvt_pk_bf16_f32 v83, v54, v55
  v_exp_f32 v58, v58
  v_exp_f32 v59, v59
  v_cvt_pk_bf16_f32 v84, v56, v57
  v_exp_f32 v60, v60
  v_mfma_f32_32x32x16_bf16 a[16:31], a[108:111], v[92:95], a[16:31]
  v_exp_f32 v61, v61
  v_cvt_pk_bf16_f32 v85, v58, v59
  v_exp_f32 v62, v62
  v_exp_f32 v63, v63
  v_cvt_pk_bf16_f32 v86, v60, v61
  v_cvt_pk_bf16_f32 v87, v62, v63
  v_mfma_f32_32x32x16_bf16 v[48:63], a[112:115], v[32:35], 0
  v_exp_f32 v64, v64
  v_exp_f32 v65, v65
  v_exp_f32 v66, v66
  v_exp_f32 v67, v67
  v_cvt_pk_bf16_f32 v88, v64, v65
  v_exp_f32 v68, v68
  v_mfma_f32_32x32x16_bf16 v[48:63], a[116:119], v[36:39], v[48:63]
  v_exp_f32 v69, v69
  v_cvt_pk_bf16_f32 v89, v66, v67
  v_exp_f32 v70, v70
  v_exp_f32 v71, v71
  v_cvt_pk_bf16_f32 v90, v68, v69
  v_exp_f32 v72, v72
  v_mfma_f32_32x32x16_bf16 a[32:47], a[104:107], v[80:83], a[32:47]
  v_exp_f32 v73, v73
  v_cvt_pk_bf16_f32 v91, v70, v71
  v_exp_f32 v74, v74
  v_exp_f32 v75, v75
  v_cvt_pk_bf16_f32 v92, v72, v73
  v_exp_f32 v76, v76
  v_mfma_f32_32x32x16_bf16 a[32:47], a[108:111], v[84:87], a[32:47]
  v_exp_f32 v77, v77
  v_cvt_pk_bf16_f32 v93, v74, v75
  v_exp_f32 v78, v78
  v_exp_f32 v79, v79
  v_cvt_pk_bf16_f32 v94, v76, v77
  v_cvt_pk_bf16_f32 v95, v78, v79
  v_mfma_f32_32x32x16_bf16 v[64:79], a[112:115], v[40:43], 0
  v_exp_f32 v48, v48
  v_exp_f32 v49, v49
  v_exp_f32 v50, v50
  v_exp_f32 v51, v51
  v_cvt_pk_bf16_f32 v80, v48, v49
  v_exp_f32 v52, v52
  v_mfma_f32_32x32x16_bf16 v[64:79], a[116:119], v[44:47], v[64:79]
  s_waitcnt vmcnt(4)
  v_exp_f32 v53, v53
  v_cvt_pk_bf16_f32 v81, v50, v51
  v_exp_f32 v54, v54
  v_exp_f32 v55, v55
  v_cvt_pk_bf16_f32 v82, v52, v53
  v_exp_f32 v56, v56
  v_mfma_f32_32x32x16_bf16 a[0:15], a[120:123], v[88:91], a[0:15]
  v_exp_f32 v57, v57
  v_cvt_pk_bf16_f32 v83, v54, v55
  v_exp_f32 v58, v58
  v_exp_f32 v59, v59
  v_cvt_pk_bf16_f32 v84, v56, v57
  v_exp_f32 v60, v60
  v_mfma_f32_32x32x16_bf16 a[0:15], a[124:127], v[92:95], a[0:15]
  s_waitcnt vmcnt(2)
  v_exp_f32 v61, v61
  v_cvt_pk_bf16_f32 v85, v58, v59
  v_exp_f32 v62, v62
  v_exp_f32 v63, v63
  v_cvt_pk_bf16_f32 v86, v60, v61
  v_cvt_pk_bf16_f32 v87, v62, v63
  v_mfma_f32_32x32x16_bf16 v[48:63], a[48:51], v[24:27], 0
  v_exp_f32 v64, v64
  v_exp_f32 v65, v65
  v_exp_f32 v66, v66
  v_exp_f32 v67, v67
  v_cvt_pk_bf16_f32 v88, v64, v65
  v_exp_f32 v68, v68
  v_mfma_f32_32x32x16_bf16 v[48:63], a[52:55], v[28:31], v[48:63]
  v_exp_f32 v69, v69
  v_cvt_pk_bf16_f32 v89, v66, v67
  v_exp_f32 v70, v70
  v_exp_f32 v71, v71
  v_cvt_pk_bf16_f32 v90, v68, v69
  v_exp_f32 v72, v72
  v_mfma_f32_32x32x16_bf16 a[16:31], a[120:123], v[80:83], a[16:31]
  v_exp_f32 v73, v73
  v_cvt_pk_bf16_f32 v91, v70, v71
  v_exp_f32 v74, v74
  v_exp_f32 v75, v75
  v_cvt_pk_bf16_f32 v92, v72, v73
  v_exp_f32 v76, v76
  v_mfma_f32_32x32x16_bf16 a[16:31], a[124:127], v[84:87], a[16:31]
  v_exp_f32 v77, v77
  v_cvt_pk_bf16_f32 v93, v74, v75
  v_exp_f32 v78, v78
  v_exp_f32 v79, v79
  v_cvt_pk_bf16_f32 v94, v76, v77
  v_cvt_pk_bf16_f32 v95, v78, v79
  v_mfma_f32_32x32x16_bf16 v[64:79], a[48:51], v[32:35], 0
  v_exp_f32 v48, v48
  v_exp_f32 v49, v49
  v_exp_f32 v50, v50
  v_exp_f32 v51, v51
  v_cvt_pk_bf16_f32 v80, v48, v49
  v_exp_f32 v52, v52
  v_mfma_f32_32x32x16_bf16 v[64:79], a[52:55], v[36:39], v[64:79]
  v_exp_f32 v53, v53
  v_cvt_pk_bf16_f32 v81, v50, v51
  v_exp_f32 v54, v54
  v_exp_f32 v55, v55
  v_cvt_pk_bf16_f32 v82, v52, v53
  v_exp_f32 v56, v56
  v_mfma_f32_32x32x16_bf16 a[32:47], a[120:123], v[88:91], a[32:47]
  v_exp_f32 v57, v57
  v_cvt_pk_bf16_f32 v83, v54, v55
  v_exp_f32 v58, v58
  v_exp_f32 v59, v59
  v_cvt_pk_bf16_f32 v84, v56, v57
  v_exp_f32 v60, v60
  v_mfma_f32_32x32x16_bf16 a[32:47], a[124:127], v[92:95], a[32:47]
  v_exp_f32 v61, v61
  v_cvt_pk_bf16_f32 v85, v58, v59
  v_exp_f32 v62, v62
  v_exp_f32 v63, v63
  v_cvt_pk_bf16_f32 v86, v60, v61
  v_cvt_pk_bf16_f32 v87, v62, v63
  v_mfma_f32_32x32x16_bf16 v[48:63], a[48:51], v[40:43], 0
  v_exp_f32 v64, v64
  v_exp_f32 v65, v65
  v_exp_f32 v66, v66
  v_exp_f32 v67, v67
  v_cvt_pk_bf16_f32 v88, v64, v65
  v_exp_f32 v68, v68
  v_mfma_f32_32x32x16_bf16 v[48:63], a[52:55], v[44:47], v[48:63]
  s_waitcnt vmcnt(0)
  v_exp_f32 v69, v69
  v_cvt_pk_bf16_f32 v89, v66, v67
  v_exp_f32 v70, v70
  v_exp_f32 v71, v71
  v_cvt_pk_bf16_f32 v90, v68, v69
  v_exp_f32 v72, v72
  v_mfma_f32_32x32x16_bf16 a[0:15], a[56:59], v[80:83], a[0:15]
  v_exp_f32 v73, v73
  v_cvt_pk_bf16_f32 v91, v70, v71
  v_exp_f32 v74, v74
  v_exp_f32 v75, v75
  v_cvt_pk_bf16_f32 v92, v72, v73
  v_exp_f32 v76, v76
  v_mfma_f32_32x32x16_bf16 a[0:15], a[60:63], v[84:87], a[0:15]
  v_exp_f32 v77, v77
  v_cvt_pk_bf16_f32 v93, v74, v75
  v_exp_f32 v78, v78
  v_exp_f32 v79, v79
  v_cvt_pk_bf16_f32 v94, v76, v77
  v_cvt_pk_bf16_f32 v95, v78, v79
  v_mfma_f32_32x32x16_bf16 v[64:79], a[64:67], v[16:19], 0
  s_barrier
  v_exp_f32 v48, v48
  v_exp_f32 v49, v49
  v_exp_f32 v50, v50
  v_exp_f32 v51, v51
  v_cvt_pk_bf16_f32 v80, v48, v49
  v_exp_f32 v52, v52
  v_mfma_f32_32x32x16_bf16 v[64:79], a[68:71], v[20:23], v[64:79]
  ds_write_b128 v112, a[0:3] offset:0
  v_exp_f32 v53, v53
  v_cvt_pk_bf16_f32 v81, v50, v51
  v_exp_f32 v54, v54
  v_exp_f32 v55, v55
  v_cvt_pk_bf16_f32 v82, v52, v53
  v_exp_f32 v56, v56
  v_mfma_f32_32x32x16_bf16 a[16:31], a[56:59], v[88:91], a[16:31]
  ds_write_b128 v112, a[4:7] offset:1024
  v_exp_f32 v57, v57
  v_cvt_pk_bf16_f32 v83, v54, v55
  v_exp_f32 v58, v58
  v_exp_f32 v59, v59
  v_cvt_pk_bf16_f32 v84, v56, v57
  v_exp_f32 v60, v60
  v_mfma_f32_32x32x16_bf16 a[16:31], a[60:63], v[92:95], a[16:31]
  ds_write_b128 v112, a[8:11] offset:2048
  v_exp_f32 v61, v61
  v_cvt_pk_bf16_f32 v85, v58, v59
  v_exp_f32 v62, v62
  v_exp_f32 v63, v63
  v_cvt_pk_bf16_f32 v86, v60, v61
  v_cvt_pk_bf16_f32 v87, v62, v63
  v_mfma_f32_32x32x16_bf16 v[48:63], a[80:83], v[16:19], 0
  ds_write_b128 v112, a[12:15] offset:3072
  v_exp_f32 v64, v64
  v_exp_f32 v65, v65
  v_exp_f32 v66, v66
  v_exp_f32 v67, v67
  v_cvt_pk_bf16_f32 v88, v64, v65
  v_exp_f32 v68, v68
  v_mfma_f32_32x32x16_bf16 v[48:63], a[84:87], v[20:23], v[48:63]
  ds_write_b128 v113, a[16:19] offset:0
  v_exp_f32 v69, v69
  v_cvt_pk_bf16_f32 v89, v66, v67
  v_exp_f32 v70, v70
  v_exp_f32 v71, v71
  v_cvt_pk_bf16_f32 v90, v68, v69
  v_exp_f32 v72, v72
  v_mfma_f32_32x32x16_bf16 a[32:47], a[56:59], v[80:83], a[32:47]
  ds_write_b128 v113, a[20:23] offset:1024
  v_exp_f32 v73, v73
  v_cvt_pk_bf16_f32 v91, v70, v71
  v_exp_f32 v74, v74
  v_exp_f32 v75, v75
  v_cvt_pk_bf16_f32 v92, v72, v73
  v_exp_f32 v76, v76
  v_mfma_f32_32x32x16_bf16 a[32:47], a[60:63], v[84:87], a[32:47]
  ds_write_b128 v113, a[24:27] offset:2048
  v_exp_f32 v77, v77
  v_cvt_pk_bf16_f32 v93, v74, v75
  v_exp_f32 v78, v78
  v_exp_f32 v79, v79
  v_cvt_pk_bf16_f32 v94, v76, v77
  v_cvt_pk_bf16_f32 v95, v78, v79
  v_mfma_f32_32x32x16_bf16 v[64:79], a[96:99], v[16:19], 0
  ds_write_b128 v113, a[28:31] offset:3072
  v_exp_f32 v48, v48
  v_exp_f32 v49, v49
  v_exp_f32 v50, v50
  v_exp_f32 v51, v51
  v_cvt_pk_bf16_f32 v80, v48, v49
  v_exp_f32 v52, v52
  v_mfma_f32_32x32x16_bf16 v[64:79], a[100:103], v[20:23], v[64:79]
  ds_write_b128 v114, a[32:35] offset:0
  v_exp_f32 v53, v53
  v_cvt_pk_bf16_f32 v81, v50, v51
  v_exp_f32 v54, v54
  v_exp_f32 v55, v55
  v_cvt_pk_bf16_f32 v82, v52, v53
  v_exp_f32 v56, v56
  v_mfma_f32_32x32x16_bf16 v[96:111], a[72:75], v[88:91], v[96:111]
  ds_write_b128 v114, a[36:39] offset:1024
  v_exp_f32 v57, v57
  v_cvt_pk_bf16_f32 v83, v54, v55
  v_exp_f32 v58, v58
  v_exp_f32 v59, v59
  v_cvt_pk_bf16_f32 v84, v56, v57
  v_exp_f32 v60, v60
  v_mfma_f32_32x32x16_bf16 v[96:111], a[76:79], v[92:95], v[96:111]
  ds_write_b128 v114, a[40:43] offset:2048
  v_exp_f32 v61, v61
  v_cvt_pk_bf16_f32 v85, v58, v59
  v_exp_f32 v62, v62
  v_exp_f32 v63, v63
  v_cvt_pk_bf16_f32 v86, v60, v61
  v_cvt_pk_bf16_f32 v87, v62, v63
  v_mfma_f32_32x32x16_bf16 v[48:63], a[112:115], v[16:19], 0
  ds_write_b128 v114, a[44:47] offset:3072
  v_exp_f32 v64, v64
  v_exp_f32 v65, v65
  v_exp_f32 v66, v66
  v_exp_f32 v67, v67
  v_cvt_pk_bf16_f32 v88, v64, v65
  v_exp_f32 v68, v68
  v_mfma_f32_32x32x16_bf16 v[48:63], a[116:119], v[20:23], v[48:63]
  v_exp_f32 v69, v69
  v_cvt_pk_bf16_f32 v89, v66, v67
  v_exp_f32 v70, v70
  v_exp_f32 v71, v71
  v_cvt_pk_bf16_f32 v90, v68, v69
  v_exp_f32 v72, v72
  v_mfma_f32_32x32x16_bf16 v[96:111], a[88:91], v[80:83], v[96:111]
  s_waitcnt lgkmcnt(0)
  s_barrier
  v_exp_f32 v73, v73
  v_cvt_pk_bf16_f32 v91, v70, v71
  v_exp_f32 v74, v74
  v_exp_f32 v75, v75
  v_cvt_pk_bf16_f32 v92, v72, v73
  v_exp_f32 v76, v76
  v_mfma_f32_32x32x16_bf16 v[96:111], a[92:95], v[84:87], v[96:111]
  ds_read_b128 v[24:27], v115 offset:0
  ds_read_b128 v[28:31], v115 offset:1024
  v_exp_f32 v77, v77
  v_cvt_pk_bf16_f32 v93, v74, v75
  v_exp_f32 v78, v78
  v_exp_f32 v79, v79
  v_cvt_pk_bf16_f32 v94, v76, v77
  v_cvt_pk_bf16_f32 v95, v78, v79
  v_mfma_f32_32x32x16_bf16 v[64:79], a[48:51], v[16:19], 0
  ds_read_b128 v[32:35], v115 offset:2048
  ds_read_b128 v[36:39], v115 offset:3072
  v_exp_f32 v48, v48
  v_exp_f32 v49, v49
  v_exp_f32 v50, v50
  v_exp_f32 v51, v51
  v_cvt_pk_bf16_f32 v80, v48, v49
  v_exp_f32 v52, v52
  v_mfma_f32_32x32x16_bf16 v[64:79], a[52:55], v[20:23], v[64:79]
  ds_read_b128 v[40:43], v115 offset:4096
  v_exp_f32 v53, v53
  v_cvt_pk_bf16_f32 v81, v50, v51
  v_exp_f32 v54, v54
  v_exp_f32 v55, v55
  v_cvt_pk_bf16_f32 v82, v52, v53
  v_exp_f32 v56, v56
  v_mfma_f32_32x32x16_bf16 v[96:111], a[104:107], v[88:91], v[96:111]
  ds_read_b128 v[44:47], v115 offset:5120
  ds_read_b128 v[4:7], v115 offset:6144
  v_exp_f32 v57, v57
  v_cvt_pk_bf16_f32 v83, v54, v55
  v_exp_f32 v58, v58
  v_exp_f32 v59, v59
  v_cvt_pk_bf16_f32 v84, v56, v57
  v_exp_f32 v60, v60
  v_mfma_f32_32x32x16_bf16 v[96:111], a[108:111], v[92:95], v[96:111]
  ds_read_b128 v[12:15], v115 offset:7168
  v_exp_f32 v61, v61
  v_cvt_pk_bf16_f32 v85, v58, v59
  v_exp_f32 v62, v62
  v_exp_f32 v63, v63
  v_cvt_pk_bf16_f32 v86, v60, v61
  v_cvt_pk_bf16_f32 v87, v62, v63
  ds_read_b128 v[48:51], v115 offset:8192
  v_exp_f32 v64, v64
  v_exp_f32 v65, v65
  v_exp_f32 v66, v66
  v_exp_f32 v67, v67
  v_cvt_pk_bf16_f32 v88, v64, v65
  v_exp_f32 v68, v68
  ds_read_b128 v[52:55], v115 offset:9216
  v_exp_f32 v69, v69
  v_cvt_pk_bf16_f32 v89, v66, v67
  v_exp_f32 v70, v70
  v_exp_f32 v71, v71
  v_cvt_pk_bf16_f32 v90, v68, v69
  v_exp_f32 v72, v72
  v_mfma_f32_32x32x16_bf16 v[96:111], a[120:123], v[80:83], v[96:111]
  ds_read_b128 v[56:59], v115 offset:10240
  v_exp_f32 v73, v73
  v_cvt_pk_bf16_f32 v91, v70, v71
  v_exp_f32 v74, v74
  v_exp_f32 v75, v75
  v_cvt_pk_bf16_f32 v92, v72, v73
  v_exp_f32 v76, v76
  v_mfma_f32_32x32x16_bf16 v[96:111], a[124:127], v[84:87], v[96:111]
  ds_read_b128 v[60:63], v115 offset:11264
  v_exp_f32 v77, v77
  v_cvt_pk_bf16_f32 v93, v74, v75
  v_exp_f32 v78, v78
  v_exp_f32 v79, v79
  v_cvt_pk_bf16_f32 v94, v76, v77
  v_cvt_pk_bf16_f32 v95, v78, v79
  v_mfma_f32_32x32x16_bf16 v[96:111], a[56:59], v[88:91], v[96:111]
  s_waitcnt lgkmcnt(4)
  v_pk_add_f32 v[24:25], v[24:25], v[40:41]
  v_pk_add_f32 v[26:27], v[26:27], v[42:43]
  v_pk_add_f32 v[28:29], v[28:29], v[44:45]
  v_pk_add_f32 v[30:31], v[30:31], v[46:47]
  v_mfma_f32_32x32x16_bf16 v[96:111], a[60:63], v[92:95], v[96:111]
  v_pk_add_f32 v[32:33], v[32:33], v[4:5]
  v_pk_add_f32 v[34:35], v[34:35], v[6:7]
  v_pk_add_f32 v[36:37], v[36:37], v[12:13]
  v_pk_add_f32 v[38:39], v[38:39], v[14:15]
  s_waitcnt lgkmcnt(0)
  v_pk_add_f32 v[24:25], v[24:25], v[48:49]
  v_pk_add_f32 v[26:27], v[26:27], v[50:51]
  v_pk_add_f32 v[28:29], v[28:29], v[52:53]
  v_pk_add_f32 v[30:31], v[30:31], v[54:55]
  v_pk_add_f32 v[32:33], v[32:33], v[56:57]
  v_pk_add_f32 v[34:35], v[34:35], v[58:59]
  v_pk_add_f32 v[36:37], v[36:37], v[60:61]
  v_pk_add_f32 v[38:39], v[38:39], v[62:63]
  v_pk_add_f32 v[108:109], v[108:109], v[36:37]
  v_pk_add_f32 v[110:111], v[110:111], v[38:39]
  v_pk_add_f32 v[96:97], v[96:97], v[24:25]
  v_pk_add_f32 v[98:99], v[98:99], v[26:27]
  v_pk_add_f32 v[100:101], v[100:101], v[28:29]
  v_pk_add_f32 v[102:103], v[102:103], v[30:31]
  v_pk_add_f32 v[104:105], v[104:105], v[32:33]
  v_pk_add_f32 v[106:107], v[106:107], v[34:35]
  v_mov_b32 v80, v108
  v_mov_b32 v81, v108
  s_nop 1
  v_permlane32_swap_b32 v80, v81
  v_pk_mul_f32 v[82:83], v[96:97], 0 op_sel_hi:[1,0]
  v_pk_fma_f32 v[82:83], v[98:99], 0, v[82:83] op_sel_hi:[1,0,1]
  v_pk_fma_f32 v[82:83], v[100:101], 0, v[82:83] op_sel_hi:[1,0,1]
  v_pk_fma_f32 v[82:83], v[102:103], 0, v[82:83] op_sel_hi:[1,0,1]
  v_pk_fma_f32 v[82:83], v[104:105], 0, v[82:83] op_sel_hi:[1,0,1]
  v_pk_fma_f32 v[82:83], v[106:107], 0, v[82:83] op_sel_hi:[1,0,1]
  v_pk_fma_f32 v[82:83], v[108:109], 0, v[82:83] op_sel_hi:[1,0,1]
  v_pk_fma_f32 v[82:83], v[110:111], 0, v[82:83] op_sel_hi:[1,0,1]
  v_cmp_o_f32 s[6:7], v82, v83
  v_cmp_le_f32 vcc, 0x39800000, v81
  s_and_b64 s[6:7], s[6:7], vcc
  v_cmp_ge_f32 vcc, 0x67800000, v81
  s_and_b64 s[6:7], s[6:7], vcc
  s_cmp_eq_u64 s[6:7], -1
  s_cbranch_scc0 SLOW
SLOWBACK:
  v_rcp_f32 v81, v81
  s_nop 1
  v_mul_f32 v96, v81, v96
  v_mul_f32 v97, v81, v97
  v_mul_f32 v98, v81, v98
  v_mul_f32 v99, v81, v99
  v_mul_f32 v100, v81, v100
  v_mul_f32 v101, v81, v101
  v_mul_f32 v102, v81, v102
  v_mul_f32 v103, v81, v103
  v_mul_f32 v104, v81, v104
  v_mul_f32 v105, v81, v105
  v_mul_f32 v106, v81, v106
  v_mul_f32 v107, v81, v107
  v_mul_f32 v108, v81, v108
  v_mul_f32 v109, v81, v109
  v_mul_f32 v110, v81, v110
  v_mul_f32 v111, v81, v111
  v_cvt_pk_bf16_f32 v84, v96, v97
  v_cvt_pk_bf16_f32 v85, v98, v99
  v_cvt_pk_bf16_f32 v86, v100, v101
  v_cvt_pk_bf16_f32 v87, v102, v103
  v_cvt_pk_bf16_f32 v88, v104, v105
  v_cvt_pk_bf16_f32 v89, v106, v107
  v_cvt_pk_bf16_f32 v90, v108, v109
  v_cvt_pk_bf16_f32 v91, v110, v111
  s_mov_b64 exec, s[80:81]
  v_mov_b32 v90, 0
  v_mov_b32 v91, 0
  s_mov_b64 exec, -1
  buffer_store_dwordx4 v[84:87], v2, s[24:27], s40 offen sc1
  buffer_store_dwordx4 v[88:91], v2, s[24:27], s40 offen offset:1024 sc1
  v_mov_b32 v92, s56
  s_mov_b64 exec, 15
  buffer_store_dword v92, v127, s[24:27], s41 offen sc1
  s_mov_b64 exec, -1
  v_mov_b32 v14, 6
  s_mov_b64 exec, 1
  ds_write_b32 v8, v14
  s_mov_b64 exec, -1
  ds_read_b64_tr_b16 a[0:1], v116 offset:0
  ds_read_b64_tr_b16 a[2:3], v116 offset:1792
  ds_read_b64_tr_b16 a[4:5], v116 offset:3584
  ds_read_b64_tr_b16 a[6:7], v120 offset:5376
  ds_read_b64_tr_b16 a[8:9], v116 offset:6272
  ds_read_b64_tr_b16 a[10:11], v116 offset:8064
  ds_read_b64_tr_b16 a[12:13], v116 offset:9856
  ds_read_b64_tr_b16 a[14:15], v120 offset:11648
  ds_read_b64_tr_b16 a[16:17], v116 offset:12544
  ds_read_b64_tr_b16 a[18:19], v116 offset:14336
  ds_read_b64_tr_b16 a[20:21], v116 offset:16128
  ds_read_b64_tr_b16 a[22:23], v120 offset:17920
  ds_read_b64_tr_b16 a[24:25], v116 offset:18816
  ds_read_b64_tr_b16 a[26:27], v116 offset:20608
  ds_read_b64_tr_b16 a[28:29], v116 offset:22400
  ds_read_b64_tr_b16 a[30:31], v120 offset:24192
  ds_read_b64_tr_b16 a[32:33], v116 offset:25088
  ds_read_b64_tr_b16 a[34:35], v116 offset:26880
  ds_read_b64_tr_b16 a[36:37], v116 offset:28672
  ds_read_b64_tr_b16 a[38:39], v120 offset:30464
  ds_read_b64_tr_b16 a[40:41], v116 offset:31360
  ds_read_b64_tr_b16 a[42:43], v116 offset:33152
  ds_read_b64_tr_b16 a[44:45], v116 offset:34944
  ds_read_b64_tr_b16 a[46:47], v120 offset:36736
  ds_read_b64_tr_b16 a[48:49], v116 offset:37632
  ds_read_b64_tr_b16 a[50:51], v116 offset:39424
  ds_read_b64_tr_b16 a[52:53], v116 offset:41216
  ds_read_b64_tr_b16 a[54:55], v120 offset:43008
  ds_read_b64_tr_b16 a[56:57], v116 offset:43904
  ds_read_b64_tr_b16 a[58:59], v116 offset:45696
  ds_read_b64_tr_b16 a[60:61], v116 offset:47488
  ds_read_b64_tr_b16 a[62:63], v120 offset:49280
  ds_read_b64_tr_b16 a[64:65], v117 offset:0
  ds_read_b64_tr_b16 a[66:67], v117 offset:1792
  ds_read_b64_tr_b16 a[68:69], v117 offset:3584
  ds_read_b64_tr_b16 a[70:71], v121 offset:5376
  ds_read_b64_tr_b16 a[72:73], v117 offset:6272
  ds_read_b64_tr_b16 a[74:75], v117 offset:8064
  ds_read_b64_tr_b16 a[76:77], v117 offset:9856
  ds_read_b64_tr_b16 a[78:79], v121 offset:11648
  ds_read_b64_tr_b16 a[80:81], v117 offset:12544
  ds_read_b64_tr_b16 a[82:83], v117 offset:14336
  ds_read_b64_tr_b16 a[84:85], v117 offset:16128
  ds_read_b64_tr_b16 a[86:87], v121 offset:17920
  ds_read_b64_tr_b16 a[88:89], v117 offset:18816
  ds_read_b64_tr_b16 a[90:91], v117 offset:20608
  ds_read_b64_tr_b16 a[92:93], v117 offset:22400
  ds_read_b64_tr_b16 a[94:95], v121 offset:24192
  ds_read_b64_tr_b16 a[96:97], v117 offset:25088
  ds_read_b64_tr_b16 a[98:99], v117 offset:26880
  ds_read_b64_tr_b16 a[100:101], v117 offset:28672
  ds_read_b64_tr_b16 a[102:103], v121 offset:30464
  ds_read_b64_tr_b16 a[104:105], v117 offset:31360
  ds_read_b64_tr_b16 a[106:107], v117 offset:33152
  ds_read_b64_tr_b16 a[108:109], v117 offset:34944
  ds_read_b64_tr_b16 a[110:111], v121 offset:36736
  ds_read_b64_tr_b16 a[112:113], v117 offset:37632
  ds_read_b64_tr_b16 a[114:115], v117 offset:39424
  ds_read_b64_tr_b16 a[116:117], v117 offset:41216
  ds_read_b64_tr_b16 a[118:119], v121 offset:43008
  ds_read_b64_tr_b16 a[120:121], v117 offset:43904
  ds_read_b64_tr_b16 a[122:123], v117 offset:45696
  ds_read_b64_tr_b16 a[124:125], v117 offset:47488
  ds_read_b64_tr_b16 a[126:127], v121 offset:49280
  v_mov_b32 v48, 0
  v_mov_b32 v49, 0
  v_mov_b32 v50, 0
  v_mov_b32 v51, 0
  v_mov_b32 v52, 0
  v_mov_b32 v53, 0
  v_mov_b32 v54, 0
  v_mov_b32 v55, 0
  v_mov_b32 v56, 0
  v_mov_b32 v57, 0
  v_mov_b32 v58, 0
  v_mov_b32 v59, 0
  v_mov_b32 v60, 0
  v_mov_b32 v61, 0
  v_mov_b32 v62, 0
  v_mov_b32 v63, 0
  s_mov_b32 s45, 0xfffffff0
  s_mov_b32 s46, 0
  s_mov_b32 s85, 0x100000
NL:
  ds_read_b32 v13, v9
  s_waitcnt lgkmcnt(0)
  v_cmp_le_u32 vcc, 7, v13
  s_andn2_b32 s3, vcc_lo, s45
  s_cbranch_scc0 NST
  s_ff1_i32_b32 s4, s3
  s_bitset1_b32 s45, s4
  s_mul_i32 s3, s4, 12288
  v_add_u32 v11, s3, v10
  ds_read_b128 v[16:19], v11 offset:0
  ds_read_b128 v[20:23], v11 offset:1024
  ds_read_b128 v[24:27], v11 offset:2048
  ds_read_b128 v[28:31], v11 offset:3072
  ds_read_b32 v13, v9
  ds_read_b128 v[32:35], v11 offset:4096
  ds_read_b128 v[36:39], v11 offset:5120
  ds_read_b128 v[40:43], v11 offset:6144
  ds_read_b128 v[44:47], v11 offset:7168
NDISP0:
  s_cmp_lt_u32 s4, 2
  s_cbranch_scc1 ND01_0
  s_cmp_eq_u32 s4, 2
  s_cbranch_scc1 NG2_0
NG3_0:
  s_waitcnt lgkmcnt(8)
  v_mfma_f32_32x32x16_bf16 v[48:63], a[96:99], v[16:19], v[48:63]
  s_waitcnt lgkmcnt(7)
  v_mfma_f32_32x32x16_bf16 v[48:63], a[100:103], v[20:23], v[48:63]
  s_waitcnt lgkmcnt(6)
  v_mfma_f32_32x32x16_bf16 v[48:63], a[104:107], v[24:27], v[48:63]
  s_waitcnt lgkmcnt(4)
  v_cmp_le_u32 vcc, 7, v13
  s_andn2_b32 s3, vcc_lo, s45
  v_mfma_f32_32x32x16_bf16 v[48:63], a[108:111], v[28:31], v[48:63]
  s_cbranch_scc0 NE3_0
  s_ff1_i32_b32 s4, s3
  s_bitset1_b32 s45, s4
  s_mul_i32 s3, s4, 12288
  v_add_u32 v11, s3, v10
  ds_read_b128 v[64:67], v11 offset:0
  ds_read_b128 v[68:71], v11 offset:1024
  s_waitcnt lgkmcnt(5)
  v_mfma_f32_32x32x16_bf16 v[48:63], a[112:115], v[32:35], v[48:63]
  ds_read_b128 v[72:75], v11 offset:2048
  ds_read_b128 v[76:79], v11 offset:3072
  s_waitcnt lgkmcnt(6)
  v_mfma_f32_32x32x16_bf16 v[48:63], a[116:119], v[36:39], v[48:63]
  ds_read_b32 v13, v9
  ds_read_b128 v[80:83], v11 offset:4096
  s_waitcnt lgkmcnt(7)
  v_mfma_f32_32x32x16_bf16 v[48:63], a[120:123], v[40:43], v[48:63]
  ds_read_b128 v[84:87], v11 offset:5120
  ds_read_b128 v[88:91], v11 offset:6144
  ds_read_b128 v[92:95], v11 offset:7168
  s_waitcnt lgkmcnt(9)
  v_mfma_f32_32x32x16_bf16 v[48:63], a[124:127], v[44:47], v[48:63]
  s_branch NDISP1
NE3_0:
  s_cmp_eq_u32 s45, -1
  s_waitcnt lgkmcnt(3)
  v_mfma_f32_32x32x16_bf16 v[48:63], a[112:115], v[32:35], v[48:63]
  s_waitcnt lgkmcnt(2)
  v_mfma_f32_32x32x16_bf16 v[48:63], a[116:119], v[36:39], v[48:63]
  s_waitcnt lgkmcnt(1)
  v_mfma_f32_32x32x16_bf16 v[48:63], a[120:123], v[40:43], v[48:63]
  s_waitcnt lgkmcnt(0)
  ds_read_b32 v13, v9
  v_mfma_f32_32x32x16_bf16 v[48:63], a[124:127], v[44:47], v[48:63]
  s_cbranch_scc1 NDONE
  s_branch NST
NG2_0:
  s_waitcnt lgkmcnt(8)
  v_mfma_f32_32x32x16_bf16 v[48:63], a[64:67], v[16:19], v[48:63]
  s_waitcnt lgkmcnt(7)
  v_mfma_f32_32x32x16_bf16 v[48:63], a[68:71], v[20:23], v[48:63]
  s_waitcnt lgkmcnt(6)
  v_mfma_f32_32x32x16_bf16 v[48:63], a[72:75], v[24:27], v[48:63]
  s_waitcnt lgkmcnt(4)
  v_cmp_le_u32 vcc, 7, v13
  s_andn2_b32 s3, vcc_lo, s45
  v_mfma_f32_32x32x16_bf16 v[48:63], a[76:79], v[28:31], v[48:63]
  s_cbranch_scc0 NE2_0
  s_ff1_i32_b32 s4, s3
  s_bitset1_b32 s45, s4
  s_mul_i32 s3, s4, 12288
  v_add_u32 v11, s3, v10
  ds_read_b128 v[64:67], v11 offset:0
  ds_read_b128 v[68:71], v11 offset:1024
  s_waitcnt lgkmcnt(5)
  v_mfma_f32_32x32x16_bf16 v[48:63], a[80:83], v[32:35], v[48:63]
  ds_read_b128 v[72:75], v11 offset:2048
  ds_read_b128 v[76:79], v11 offset:3072
  s_waitcnt lgkmcnt(6)
  v_mfma_f32_32x32x16_bf16 v[48:63], a[84:87], v[36:39], v[48:63]
  ds_read_b32 v13, v9
  ds_read_b128 v[80:83], v11 offset:4096
  s_waitcnt lgkmcnt(7)
  v_mfma_f32_32x32x16_bf16 v[48:63], a[88:91], v[40:43], v[48:63]
  ds_read_b128 v[84:87], v11 offset:5120
  ds_read_b128 v[88:91], v11 offset:6144
  ds_read_b128 v[92:95], v11 offset:7168
  s_waitcnt lgkmcnt(9)
  v_mfma_f32_32x32x16_bf16 v[48:63], a[92:95], v[44:47], v[48:63]
  s_branch NDISP1
NE2_0:
  s_cmp_eq_u32 s45, -1
  s_waitcnt lgkmcnt(3)
  v_mfma_f32_32x32x16_bf16 v[48:63], a[80:83], v[32:35], v[48:63]
  s_waitcnt lgkmcnt(2)
  v_mfma_f32_32x32x16_bf16 v[48:63], a[84:87], v[36:39], v[48:63]
  s_waitcnt lgkmcnt(1)
  v_mfma_f32_32x32x16_bf16 v[48:63], a[88:91], v[40:43], v[48:63]
  s_waitcnt lgkmcnt(0)
  ds_read_b32 v13, v9
  v_mfma_f32_32x32x16_bf16 v[48:63], a[92:95], v[44:47], v[48:63]
  s_cbranch_scc1 NDONE
  s_branch NST
ND01_0:
  s_cmp_eq_u32 s4, 0
  s_cbranch_scc1 NG0_0
NG1_0:
  s_waitcnt lgkmcnt(8)
  v_mfma_f32_32x32x16_bf16 v[48:63], a[32:35], v[16:19], v[48:63]
  s_waitcnt lgkmcnt(7)
  v_mfma_f32_32x32x16_bf16 v[48:63], a[36:39], v[20:23], v[48:63]
  s_waitcnt lgkmcnt(6)
  v_mfma_f32_32x32x16_bf16 v[48:63], a[40:43], v[24:27], v[48:63]
  s_waitcnt lgkmcnt(4)
  v_cmp_le_u32 vcc, 7, v13
  s_andn2_b32 s3, vcc_lo, s45
  v_mfma_f32_32x32x16_bf16 v[48:63], a[44:47], v[28:31], v[48:63]
  s_cbranch_scc0 NE1_0
  s_ff1_i32_b32 s4, s3
  s_bitset1_b32 s45, s4
  s_mul_i32 s3, s4, 12288
  v_add_u32 v11, s3, v10
  ds_read_b128 v[64:67], v11 offset:0
  ds_read_b128 v[68:71], v11 offset:1024
  s_waitcnt lgkmcnt(5)
  v_mfma_f32_32x32x16_bf16 v[48:63], a[48:51], v[32:35], v[48:63]
  ds_read_b128 v[72:75], v11 offset:2048
  ds_read_b128 v[76:79], v11 offset:3072
  s_waitcnt lgkmcnt(6)
  v_mfma_f32_32x32x16_bf16 v[48:63], a[52:55], v[36:39], v[48:63]
  ds_read_b32 v13, v9
  ds_read_b128 v[80:83], v11 offset:4096
  s_waitcnt lgkmcnt(7)
  v_mfma_f32_32x32x16_bf16 v[48:63], a[56:59], v[40:43], v[48:63]
  ds_read_b128 v[84:87], v11 offset:5120
  ds_read_b128 v[88:91], v11 offset:6144
  ds_read_b128 v[92:95], v11 offset:7168
  s_waitcnt lgkmcnt(9)
  v_mfma_f32_32x32x16_bf16 v[48:63], a[60:63], v[44:47], v[48:63]
  s_branch NDISP1
NE1_0:
  s_cmp_eq_u32 s45, -1
  s_waitcnt lgkmcnt(3)
  v_mfma_f32_32x32x16_bf16 v[48:63], a[48:51], v[32:35], v[48:63]
  s_waitcnt lgkmcnt(2)
  v_mfma_f32_32x32x16_bf16 v[48:63], a[52:55], v[36:39], v[48:63]
  s_waitcnt lgkmcnt(1)
  v_mfma_f32_32x32x16_bf16 v[48:63], a[56:59], v[40:43], v[48:63]
  s_waitcnt lgkmcnt(0)
  ds_read_b32 v13, v9
  v_mfma_f32_32x32x16_bf16 v[48:63], a[60:63], v[44:47], v[48:63]
  s_cbranch_scc1 NDONE
  s_branch NST
NG0_0:
  s_waitcnt lgkmcnt(8)
  v_mfma_f32_32x32x16_bf16 v[48:63], a[0:3], v[16:19], v[48:63]
  s_waitcnt lgkmcnt(7)
  v_mfma_f32_32x32x16_bf16 v[48:63], a[4:7], v[20:23], v[48:63]
  s_waitcnt lgkmcnt(6)
  v_mfma_f32_32x32x16_bf16 v[48:63], a[8:11], v[24:27], v[48:63]
  s_waitcnt lgkmcnt(4)
  v_cmp_le_u32 vcc, 7, v13
  s_andn2_b32 s3, vcc_lo, s45
  v_mfma_f32_32x32x16_bf16 v[48:63], a[12:15], v[28:31], v[48:63]
  s_cbranch_scc0 NE0_0
  s_ff1_i32_b32 s4, s3
  s_bitset1_b32 s45, s4
  s_mul_i32 s3, s4, 12288
  v_add_u32 v11, s3, v10
  ds_read_b128 v[64:67], v11 offset:0
  ds_read_b128 v[68:71], v11 offset:1024
  s_waitcnt lgkmcnt(5)
  v_mfma_f32_32x32x16_bf16 v[48:63], a[16:19], v[32:35], v[48:63]
  ds_read_b128 v[72:75], v11 offset:2048
  ds_read_b128 v[76:79], v11 offset:3072
  s_waitcnt lgkmcnt(6)
  v_mfma_f32_32x32x16_bf16 v[48:63], a[20:23], v[36:39], v[48:63]
  ds_read_b32 v13, v9
  ds_read_b128 v[80:83], v11 offset:4096
  s_waitcnt lgkmcnt(7)
  v_mfma_f32_32x32x16_bf16 v[48:63], a[24:27], v[40:43], v[48:63]
  ds_read_b128 v[84:87], v11 offset:5120
  ds_read_b128 v[88:91], v11 offset:6144
  ds_read_b128 v[92:95], v11 offset:7168
  s_waitcnt lgkmcnt(9)
  v_mfma_f32_32x32x16_bf16 v[48:63], a[28:31], v[44:47], v[48:63]
  s_branch NDISP1
NE0_0:
  s_cmp_eq_u32 s45, -1
  s_waitcnt lgkmcnt(3)
  v_mfma_f32_32x32x16_bf16 v[48:63], a[16:19], v[32:35], v[48:63]
  s_waitcnt lgkmcnt(2)
  v_mfma_f32_32x32x16_bf16 v[48:63], a[20:23], v[36:39], v[48:63]
  s_waitcnt lgkmcnt(1)
  v_mfma_f32_32x32x16_bf16 v[48:63], a[24:27], v[40:43], v[48:63]
  s_waitcnt lgkmcnt(0)
  ds_read_b32 v13, v9
  v_mfma_f32_32x32x16_bf16 v[48:63], a[28:31], v[44:47], v[48:63]
  s_cbranch_scc1 NDONE
  s_branch NST
NDISP1:
  s_cmp_lt_u32 s4, 2
  s_cbranch_scc1 ND01_1
  s_cmp_eq_u32 s4, 2
  s_cbranch_scc1 NG2_1
NG3_1:
  s_waitcnt lgkmcnt(8)
  v_mfma_f32_32x32x16_bf16 v[48:63], a[96:99], v[64:67], v[48:63]
  s_waitcnt lgkmcnt(7)
  v_mfma_f32_32x32x16_bf16 v[48:63], a[100:103], v[68:71], v[48:63]
  s_waitcnt lgkmcnt(6)
  v_mfma_f32_32x32x16_bf16 v[48:63], a[104:107], v[72:75], v[48:63]
  s_waitcnt lgkmcnt(4)
  v_cmp_le_u32 vcc, 7, v13
  s_andn2_b32 s3, vcc_lo, s45
  v_mfma_f32_32x32x16_bf16 v[48:63], a[108:111], v[76:79], v[48:63]
  s_cbranch_scc0 NE3_1
  s_ff1_i32_b32 s4, s3
  s_bitset1_b32 s45, s4
  s_mul_i32 s3, s4, 12288
  v_add_u32 v11, s3, v10
  ds_read_b128 v[16:19], v11 offset:0
  ds_read_b128 v[20:23], v11 offset:1024
  s_waitcnt lgkmcnt(5)
  v_mfma_f32_32x32x16_bf16 v[48:63], a[112:115], v[80:83], v[48:63]
  ds_read_b128 v[24:27], v11 offset:2048
  ds_read_b128 v[28:31], v11 offset:3072
  s_waitcnt lgkmcnt(6)
  v_mfma_f32_32x32x16_bf16 v[48:63], a[116:119], v[84:87], v[48:63]
  ds_read_b32 v13, v9
  ds_read_b128 v[32:35], v11 offset:4096
  s_waitcnt lgkmcnt(7)
  v_mfma_f32_32x32x16_bf16 v[48:63], a[120:123], v[88:91], v[48:63]
  ds_read_b128 v[36:39], v11 offset:5120
  ds_read_b128 v[40:43], v11 offset:6144
  ds_read_b128 v[44:47], v11 offset:7168
  s_waitcnt lgkmcnt(9)
  v_mfma_f32_32x32x16_bf16 v[48:63], a[124:127], v[92:95], v[48:63]
  s_branch NDISP0
NE3_1:
  s_cmp_eq_u32 s45, -1
  s_waitcnt lgkmcnt(3)
  v_mfma_f32_32x32x16_bf16 v[48:63], a[112:115], v[80:83], v[48:63]
  s_waitcnt lgkmcnt(2)
  v_mfma_f32_32x32x16_bf16 v[48:63], a[116:119], v[84:87], v[48:63]
  s_waitcnt lgkmcnt(1)
  v_mfma_f32_32x32x16_bf16 v[48:63], a[120:123], v[88:91], v[48:63]
  s_waitcnt lgkmcnt(0)
  ds_read_b32 v13, v9
  v_mfma_f32_32x32x16_bf16 v[48:63], a[124:127], v[92:95], v[48:63]
  s_cbranch_scc1 NDONE
  s_branch NST
NG2_1:
  s_waitcnt lgkmcnt(8)
  v_mfma_f32_32x32x16_bf16 v[48:63], a[64:67], v[64:67], v[48:63]
  s_waitcnt lgkmcnt(7)
  v_mfma_f32_32x32x16_bf16 v[48:63], a[68:71], v[68:71], v[48:63]
  s_waitcnt lgkmcnt(6)
  v_mfma_f32_32x32x16_bf16 v[48:63], a[72:75], v[72:75], v[48:63]
  s_waitcnt lgkmcnt(4)
  v_cmp_le_u32 vcc, 7, v13
  s_andn2_b32 s3, vcc_lo, s45
  v_mfma_f32_32x32x16_bf16 v[48:63], a[76:79], v[76:79], v[48:63]
  s_cbranch_scc0 NE2_1
  s_ff1_i32_b32 s4, s3
  s_bitset1_b32 s45, s4
  s_mul_i32 s3, s4, 12288
  v_add_u32 v11, s3, v10
  ds_read_b128 v[16:19], v11 offset:0
  ds_read_b128 v[20:23], v11 offset:1024
  s_waitcnt lgkmcnt(5)
  v_mfma_f32_32x32x16_bf16 v[48:63], a[80:83], v[80:83], v[48:63]
  ds_read_b128 v[24:27], v11 offset:2048
  ds_read_b128 v[28:31], v11 offset:3072
  s_waitcnt lgkmcnt(6)
  v_mfma_f32_32x32x16_bf16 v[48:63], a[84:87], v[84:87], v[48:63]
  ds_read_b32 v13, v9
  ds_read_b128 v[32:35], v11 offset:4096
  s_waitcnt lgkmcnt(7)
  v_mfma_f32_32x32x16_bf16 v[48:63], a[88:91], v[88:91], v[48:63]
  ds_read_b128 v[36:39], v11 offset:5120
  ds_read_b128 v[40:43], v11 offset:6144
  ds_read_b128 v[44:47], v11 offset:7168
  s_waitcnt lgkmcnt(9)
  v_mfma_f32_32x32x16_bf16 v[48:63], a[92:95], v[92:95], v[48:63]
  s_branch NDISP0
NE2_1:
  s_cmp_eq_u32 s45, -1
  s_waitcnt lgkmcnt(3)
  v_mfma_f32_32x32x16_bf16 v[48:63], a[80:83], v[80:83], v[48:63]
  s_waitcnt lgkmcnt(2)
  v_mfma_f32_32x32x16_bf16 v[48:63], a[84:87], v[84:87], v[48:63]
  s_waitcnt lgkmcnt(1)
  v_mfma_f32_32x32x16_bf16 v[48:63], a[88:91], v[88:91], v[48:63]
  s_waitcnt lgkmcnt(0)
  ds_read_b32 v13, v9
  v_mfma_f32_32x32x16_bf16 v[48:63], a[92:95], v[92:95], v[48:63]
  s_cbranch_scc1 NDONE
  s_branch NST
ND01_1:
  s_cmp_eq_u32 s4, 0
  s_cbranch_scc1 NG0_1
NG1_1:
  s_waitcnt lgkmcnt(8)
  v_mfma_f32_32x32x16_bf16 v[48:63], a[32:35], v[64:67], v[48:63]
  s_waitcnt lgkmcnt(7)
  v_mfma_f32_32x32x16_bf16 v[48:63], a[36:39], v[68:71], v[48:63]
  s_waitcnt lgkmcnt(6)
  v_mfma_f32_32x32x16_bf16 v[48:63], a[40:43], v[72:75], v[48:63]
  s_waitcnt lgkmcnt(4)
  v_cmp_le_u32 vcc, 7, v13
  s_andn2_b32 s3, vcc_lo, s45
  v_mfma_f32_32x32x16_bf16 v[48:63], a[44:47], v[76:79], v[48:63]
  s_cbranch_scc0 NE1_1
  s_ff1_i32_b32 s4, s3
  s_bitset1_b32 s45, s4
  s_mul_i32 s3, s4, 12288
  v_add_u32 v11, s3, v10
  ds_read_b128 v[16:19], v11 offset:0
  ds_read_b128 v[20:23], v11 offset:1024
  s_waitcnt lgkmcnt(5)
  v_mfma_f32_32x32x16_bf16 v[48:63], a[48:51], v[80:83], v[48:63]
  ds_read_b128 v[24:27], v11 offset:2048
  ds_read_b128 v[28:31], v11 offset:3072
  s_waitcnt lgkmcnt(6)
  v_mfma_f32_32x32x16_bf16 v[48:63], a[52:55], v[84:87], v[48:63]
  ds_read_b32 v13, v9
  ds_read_b128 v[32:35], v11 offset:4096
  s_waitcnt lgkmcnt(7)
  v_mfma_f32_32x32x16_bf16 v[48:63], a[56:59], v[88:91], v[48:63]
  ds_read_b128 v[36:39], v11 offset:5120
  ds_read_b128 v[40:43], v11 offset:6144
  ds_read_b128 v[44:47], v11 offset:7168
  s_waitcnt lgkmcnt(9)
  v_mfma_f32_32x32x16_bf16 v[48:63], a[60:63], v[92:95], v[48:63]
  s_branch NDISP0
NE1_1:
  s_cmp_eq_u32 s45, -1
  s_waitcnt lgkmcnt(3)
  v_mfma_f32_32x32x16_bf16 v[48:63], a[48:51], v[80:83], v[48:63]
  s_waitcnt lgkmcnt(2)
  v_mfma_f32_32x32x16_bf16 v[48:63], a[52:55], v[84:87], v[48:63]
  s_waitcnt lgkmcnt(1)
  v_mfma_f32_32x32x16_bf16 v[48:63], a[56:59], v[88:91], v[48:63]
  s_waitcnt lgkmcnt(0)
  ds_read_b32 v13, v9
  v_mfma_f32_32x32x16_bf16 v[48:63], a[60:63], v[92:95], v[48:63]
  s_cbranch_scc1 NDONE
  s_branch NST
NG0_1:
  s_waitcnt lgkmcnt(8)
  v_mfma_f32_32x32x16_bf16 v[48:63], a[0:3], v[64:67], v[48:63]
  s_waitcnt lgkmcnt(7)
  v_mfma_f32_32x32x16_bf16 v[48:63], a[4:7], v[68:71], v[48:63]
  s_waitcnt lgkmcnt(6)
  v_mfma_f32_32x32x16_bf16 v[48:63], a[8:11], v[72:75], v[48:63]
  s_waitcnt lgkmcnt(4)
  v_cmp_le_u32 vcc, 7, v13
  s_andn2_b32 s3, vcc_lo, s45
  v_mfma_f32_32x32x16_bf16 v[48:63], a[12:15], v[76:79], v[48:63]
  s_cbranch_scc0 NE0_1
  s_ff1_i32_b32 s4, s3
  s_bitset1_b32 s45, s4
  s_mul_i32 s3, s4, 12288
  v_add_u32 v11, s3, v10
  ds_read_b128 v[16:19], v11 offset:0
  ds_read_b128 v[20:23], v11 offset:1024
  s_waitcnt lgkmcnt(5)
  v_mfma_f32_32x32x16_bf16 v[48:63], a[16:19], v[80:83], v[48:63]
  ds_read_b128 v[24:27], v11 offset:2048
  ds_read_b128 v[28:31], v11 offset:3072
  s_waitcnt lgkmcnt(6)
  v_mfma_f32_32x32x16_bf16 v[48:63], a[20:23], v[84:87], v[48:63]
  ds_read_b32 v13, v9
  ds_read_b128 v[32:35], v11 offset:4096
  s_waitcnt lgkmcnt(7)
  v_mfma_f32_32x32x16_bf16 v[48:63], a[24:27], v[88:91], v[48:63]
  ds_read_b128 v[36:39], v11 offset:5120
  ds_read_b128 v[40:43], v11 offset:6144
  ds_read_b128 v[44:47], v11 offset:7168
  s_waitcnt lgkmcnt(9)
  v_mfma_f32_32x32x16_bf16 v[48:63], a[28:31], v[92:95], v[48:63]
  s_branch NDISP0
NE0_1:
  s_cmp_eq_u32 s45, -1
  s_waitcnt lgkmcnt(3)
  v_mfma_f32_32x32x16_bf16 v[48:63], a[16:19], v[80:83], v[48:63]
  s_waitcnt lgkmcnt(2)
  v_mfma_f32_32x32x16_bf16 v[48:63], a[20:23], v[84:87], v[48:63]
  s_waitcnt lgkmcnt(1)
  v_mfma_f32_32x32x16_bf16 v[48:63], a[24:27], v[88:91], v[48:63]
  s_waitcnt lgkmcnt(0)
  ds_read_b32 v13, v9
  v_mfma_f32_32x32x16_bf16 v[48:63], a[28:31], v[92:95], v[48:63]
  s_cbranch_scc1 NDONE
  s_branch NST
NST:
NCH:
  s_sub_u32 s85, s85, 1
  s_cbranch_scc0 NL
NDONE:
  s_waitcnt lgkmcnt(0)
  v_cmp_ne_u32 vcc, 9, v13
  s_cbranch_vccnz NVER
NOK:
  s_nop 7
  v_cvt_pk_bf16_f32 v16, v48, v49
  v_cvt_pk_bf16_f32 v17, v50, v51
  v_cvt_pk_bf16_f32 v18, v52, v53
  v_cvt_pk_bf16_f32 v19, v54, v55
  v_cvt_pk_bf16_f32 v20, v56, v57
  v_cvt_pk_bf16_f32 v21, v58, v59
  v_cvt_pk_bf16_f32 v22, v60, v61
  v_cvt_pk_bf16_f32 v23, v62, v63
  v_permlane32_swap_b32 v16, v18
  v_permlane32_swap_b32 v17, v19
  v_permlane32_swap_b32 v20, v22
  v_permlane32_swap_b32 v21, v23
  buffer_store_dwordx4 v[16:19], v124, s[28:31], 0 offen
  s_cmp_eq_u32 s32, 3
  s_cbranch_scc1 NOP1
  buffer_store_dwordx4 v[20:23], v124, s[28:31], 0 offen offset:32
  s_or_b32 s3, s2, s32
  s_cbranch_scc1 NOP1
  v_mov_b32 v13, 6684672
  v_mov_b32 v14, s56
  s_mov_b64 exec, 1
  buffer_store_dword v14, v13, s[24:27], 0 offen sc1
  s_mov_b64 exec, -1
NOP1:
KEND:
  s_endpgm
SLOW:
  s_waitcnt vmcnt(0) lgkmcnt(0)
  s_lshl_b32 s6, s35, 18
  s_add_u32 s7, s6, 262144
  v_mov_b32 v80, 0xff800000
  v_mov_b32 v72, 0x3f803f80
  v_mov_b32 v73, 0x3f803f80
  v_mov_b32 v74, 0x3f803f80
  v_mov_b32 v75, 0x3f803f80
  v_mov_b32 v76, 0x3f803f80
  v_mov_b32 v77, 0x3f803f80
  v_mov_b32 v78, 0x3f803f80
  v_mov_b32 v79, 0x3f803f80
SLOWA:
  buffer_load_dwordx4 v[64:67], v2, s[24:27], s6 offen offset:0 sc1
  buffer_load_dwordx4 v[68:71], v2, s[24:27], s6 offen offset:1024 sc1
  s_waitcnt vmcnt(0)
  v_mfma_f32_32x32x16_bf16 v[32:47], v[64:67], v[16:19], 0
  v_mfma_f32_32x32x16_bf16 v[32:47], v[68:71], v[20:23], v[32:47]
  s_nop 11
  v_max3_f32 v80, v32, v33, v80
  v_max3_f32 v80, v34, v35, v80
  v_max3_f32 v80, v36, v37, v80
  v_max3_f32 v80, v38, v39, v80
  v_max3_f32 v80, v40, v41, v80
  v_max3_f32 v80, v42, v43, v80
  v_max3_f32 v80, v44, v45, v80
  v_max3_f32 v80, v46, v47, v80
  s_add_u32 s6, s6, 4096
  s_cmp_lt_u32 s6, s7
  s_cbranch_scc1 SLOWA
  v_mov_b32 v81, v80
  s_lshl_b32 s6, s35, 18
  s_nop 1
  v_permlane32_swap_b32 v80, v81
  s_nop 1
  v_max_f32 v80, v80, v81
  v_mov_b32 v96, 0
  v_mov_b32 v97, 0
  v_mov_b32 v98, 0
  v_mov_b32 v99, 0
  v_mov_b32 v100, 0
  v_mov_b32 v101, 0
  v_mov_b32 v102, 0
  v_mov_b32 v103, 0
  v_mov_b32 v104, 0
  v_mov_b32 v105, 0
  v_mov_b32 v106, 0
  v_mov_b32 v107, 0
  v_mov_b32 v108, 0
  v_mov_b32 v109, 0
  v_mov_b32 v110, 0
  v_mov_b32 v111, 0
SLOWB:
  buffer_load_dwordx4 v[64:67], v2, s[24:27], s6 offen offset:0 sc1
  buffer_load_dwordx4 v[68:71], v2, s[24:27], s6 offen offset:1024 sc1
  s_mov_b64 exec, s[82:83]
  buffer_load_dwordx4 v[72:75], v2, s[24:27], s6 offen offset:2048 sc1
  buffer_load_dwordx4 v[76:79], v2, s[24:27], s6 offen offset:3072 sc1
  s_mov_b64 exec, -1
  s_waitcnt vmcnt(0)
  v_mfma_f32_32x32x16_bf16 v[32:47], v[64:67], v[16:19], 0
  v_mfma_f32_32x32x16_bf16 v[32:47], v[68:71], v[20:23], v[32:47]
  s_nop 11
  v_sub_f32 v32, v32, v80
  v_sub_f32 v33, v33, v80
  v_sub_f32 v34, v34, v80
  v_sub_f32 v35, v35, v80
  v_sub_f32 v36, v36, v80
  v_sub_f32 v37, v37, v80
  v_sub_f32 v38, v38, v80
  v_sub_f32 v39, v39, v80
  v_sub_f32 v40, v40, v80
  v_sub_f32 v41, v41, v80
  v_sub_f32 v42, v42, v80
  v_sub_f32 v43, v43, v80
  v_sub_f32 v44, v44, v80
  v_sub_f32 v45, v45, v80
  v_sub_f32 v46, v46, v80
  v_sub_f32 v47, v47, v80
  v_exp_f32 v32, v32
  v_exp_f32 v33, v33
  v_exp_f32 v34, v34
  v_exp_f32 v35, v35
  v_exp_f32 v36, v36
  v_exp_f32 v37, v37
  v_exp_f32 v38, v38
  v_exp_f32 v39, v39
  v_exp_f32 v40, v40
  v_exp_f32 v41, v41
  v_exp_f32 v42, v42
  v_exp_f32 v43, v43
  v_exp_f32 v44, v44
  v_exp_f32 v45, v45
  v_exp_f32 v46, v46
  v_exp_f32 v47, v47
  v_cvt_pk_bf16_f32 v48, v32, v33
  v_cvt_pk_bf16_f32 v49, v34, v35
  v_cvt_pk_bf16_f32 v50, v36, v37
  v_cvt_pk_bf16_f32 v51, v38, v39
  v_cvt_pk_bf16_f32 v52, v40, v41
  v_cvt_pk_bf16_f32 v53, v42, v43
  v_cvt_pk_bf16_f32 v54, v44, v45
  v_cvt_pk_bf16_f32 v55, v46, v47
  v_mfma_f32_32x32x16_bf16 v[96:111], v[72:75], v[48:51], v[96:111]
  s_nop 0
  v_mfma_f32_32x32x16_bf16 v[96:111], v[76:79], v[52:55], v[96:111]
  s_add_u32 s6, s6, 4096
  s_cmp_lt_u32 s6, s7
  s_cbranch_scc1 SLOWB
  s_nop 8
  v_mov_b32 v80, v108
  v_mov_b32 v81, v108
  s_nop 1
  v_permlane32_swap_b32 v80, v81
  s_branch SLOWBACK
MMC1:
  s_mov_b32 s85, 0x40000
MMC1C:
  ds_read_b128 v[96:99], v5
  s_sub_u32 s85, s85, 1
  s_waitcnt lgkmcnt(0)
  s_cbranch_scc1 MMC1D
  v_min3_u32 v96, v96, v97, v98
  v_min_u32 v96, v96, v99
  s_nop 0
  v_readfirstlane_b32 s3, v96
  s_cmp_ge_u32 s3, 1
  s_cbranch_scc0 MMC1C
  s_branch MMC1D
MMC2:
  s_mov_b32 s85, 0x40000
MMC2C:
  ds_read_b128 v[96:99], v5
  s_sub_u32 s85, s85, 1
  s_waitcnt lgkmcnt(0)
  s_cbranch_scc1 MMC2D
  v_min3_u32 v96, v96, v97, v98
  v_min_u32 v96, v96, v99
  s_nop 0
  v_readfirstlane_b32 s3, v96
  s_cmp_ge_u32 s3, 2
  s_cbranch_scc0 MMC2C
  s_branch MMC2D
MMC3:
  s_mov_b32 s85, 0x40000
MMC3C:
  ds_read_b128 v[96:99], v5
  s_sub_u32 s85, s85, 1
  s_waitcnt lgkmcnt(0)
  s_cbranch_scc1 MMC3D
  v_min3_u32 v96, v96, v97, v98
  v_min_u32 v96, v96, v99
  s_nop 0
  v_readfirstlane_b32 s3, v96
  s_cmp_ge_u32 s3, 1
  s_cbranch_scc0 MMC3C
  s_branch MMC3D
MMC4:
  s_mov_b32 s85, 0x40000
MMC4C:
  ds_read_b128 v[96:99], v5
  s_sub_u32 s85, s85, 1
  s_waitcnt lgkmcnt(0)
  s_cbranch_scc1 MMC4D
  v_min3_u32 v96, v96, v97, v98
  v_min_u32 v96, v96, v99
  s_nop 0
  v_readfirstlane_b32 s3, v96
  s_cmp_ge_u32 s3, 2
  s_cbranch_scc0 MMC4C
  s_branch MMC4D
MMC5:
  s_mov_b32 s85, 0x40000
MMC5C:
  ds_read_b128 v[96:99], v5
  s_sub_u32 s85, s85, 1
  s_waitcnt lgkmcnt(0)
  s_cbranch_scc1 MMC5D
  v_min3_u32 v96, v96, v97, v98
  v_min_u32 v96, v96, v99
  s_nop 0
  v_readfirstlane_b32 s3, v96
  s_cmp_ge_u32 s3, 3
  s_cbranch_scc0 MMC5C
  s_branch MMC5D
MMC6:
  s_mov_b32 s85, 0x40000
MMC6C:
  ds_read_b128 v[52:55], v5
  s_sub_u32 s85, s85, 1
  s_waitcnt lgkmcnt(0)
  s_cbranch_scc1 MMC6D
  v_min3_u32 v52, v52, v53, v54
  v_min_u32 v52, v52, v55
  s_nop 0
  v_readfirstlane_b32 s3, v52
  s_cmp_ge_u32 s3, 4
  s_cbranch_scc0 MMC6C
  s_branch MMC6D
NVER:
  v_cmp_gt_u32 vcc, 9, v13
  s_cbranch_vccz NV2
  ds_read_b32 v13, v9
  s_sub_u32 s85, s85, 1
  s_cbranch_scc0 NDONE
  s_waitcnt lgkmcnt(0)
  s_branch NOK
NV2:
  s_cmp_lg_u32 s46, 0
  s_cbranch_scc1 NOK
  s_mov_b32 s46, 1
  s_mov_b32 s45, 0xfffffff0
  s_nop 1
  v_mov_b32 v48, 0
  v_mov_b32 v49, 0
  v_mov_b32 v50, 0
  v_mov_b32 v51, 0
  v_mov_b32 v52, 0
  v_mov_b32 v53, 0
  v_mov_b32 v54, 0
  v_mov_b32 v55, 0
  v_mov_b32 v56, 0
  v_mov_b32 v57, 0
  v_mov_b32 v58, 0
  v_mov_b32 v59, 0
  v_mov_b32 v60, 0
  v_mov_b32 v61, 0
  v_mov_b32 v62, 0
  v_mov_b32 v63, 0
  s_branch NL
HELPER:
  s_setprio 1
  s_sub_u32 s61, s32, 4
  s_lshl_b32 s53, s33, 6
  s_cmp_eq_u32 s33, 7
  s_cselect_b32 s53, 0, s53
  s_cselect_b32 s64, 0x40000000, 0
  s_lshl_b32 s65, s53, 1
  s_lshl_b32 s3, s34, 1
  s_add_u32 s53, s53, s3
  s_lshr_b32 s3, s61, 1
  s_add_u32 s66, s3, s53
  s_lshl_b32 s3, s66, 9
  v_and_b32 v11, 127, v0
  v_lshl_add_u32 v11, v11, 2, s3
  s_lshl_b32 s6, s53, 1
  v_lshrrev_b32 v12, 1, v1
  v_mul_u32_u24 v12, 896, v12
  v_and_b32 v13, 1, v1
  v_lshl_add_u32 v12, v13, 4, v12
  s_mul_i32 s3, s34, 57344
  s_add_u32 s3, s3, s65
  s_lshl_b32 s5, s61, 5
  s_add_u32 s3, s3, s5
  v_add_u32 v12, s3, v12
  s_mov_b32 s22, 1835008
  s_mov_b32 s23, 0x20000
  s_lshr_b32 s79, s61, 1
  s_mul_i32 s79, s79, 8320
  s_add_u32 s79, s79, 144384
  s_and_b32 s5, s61, 1
  s_lshl_b32 s5, s5, 11
  s_add_u32 s5, s5, s79
  s_mov_b32 s67, 28672
  s_waitcnt lgkmcnt(0)
  global_load_dword v64, v11, s[36:37]
  global_load_dword v65, v11, s[38:39]
  global_load_dword v66, v11, s[40:41]
  global_load_dword v67, v11, s[42:43]
  global_load_dword v68, v11, s[44:45]
  global_load_dword v69, v11, s[46:47]
  s_load_dword s58, s[48:49], s6
  s_load_dword s59, s[50:51], s6
  s_load_dword s60, s[24:25], s7
  s_mov_b32 m0, s5
  s_mul_i32 s62, s61, 8448
  buffer_load_dwordx4 v12, s[20:23], 0 offen lds
  s_add_u32 m0, s5, 1024
  s_add_u32 s62, s62, 110592
  buffer_load_dwordx4 v12, s[20:23], s67 offen lds
  s_setprio 1
  s_mov_b32 s18, 401408
  s_mov_b32 s19, 0x20000
  s_mov_b32 s30, 3670016
  s_mov_b32 s31, 0x20000
  s_mov_b32 s80, -1
  s_mov_b32 s81, 0x00ffffff
  s_and_b32 s54, s34, 3
  s_lshl_b32 s3, s61, 2
  s_add_u32 s3, s3, 161024
  v_mov_b32 v4, s3
  v_xor_b32 v5, 4, v4
  v_mov_b32 v13, 0
  ds_write_b32 v4, v13
  v_lshrrev_b32 v11, 5, v1
  v_and_b32 v12, 31, v1
  v_and_b32 v13, 15, v1
  v_lshrrev_b32 v14, 2, v13
  v_bfe_u32 v15, v1, 4, 2
  v_lshl_add_u32 v71, v1, 3, s62
  v_mul_u32_u24 v72, 528, v13
  v_lshl_add_u32 v72, v15, 4, v72
  v_add_u32 v72, s62, v72
  v_lshl_add_u32 v6, v15, 3, v14
  v_lshlrev_b32 v6, 5, v6
  v_and_b32 v33, 3, v1
  v_lshl_add_u32 v6, v33, 3, v6
  v_add_u32 v6, s5, v6
  v_mov_b32 v3, 161088
  v_add_u32 v42, 2112, v71
  v_add_u32 v43, 4224, v71
  v_add_u32 v44, 6336, v71
  v_lshlrev_b32 v7, 12, v13
  v_lshl_add_u32 v7, v15, 4, v7
  s_lshl_b32 s3, s33, 2
  s_add_u32 s3, s3, s61
  s_lshl_b32 s68, s3, 16
  s_lshl_b32 s5, s34, 7
  s_add_u32 s68, s68, s5
  s_add_u32 s5, s68, s64
  s_add_u32 s5, s5, 8388608
  v_add_u32 v7, s5, v7
  s_lshl_b32 s69, s3, 10
  s_lshl_b32 s5, s34, 2
  s_add_u32 s69, s69, s5
  s_add_u32 s69, s69, 6356992
  s_lshl_b32 s3, s33, 5
  s_add_u32 s3, s3, s34
  s_lshl_b32 s71, s3, 7
  s_add_u32 s71, s71, 6356992
  s_lshl_b32 s72, s3, 2
  s_add_u32 s72, s72, s61
  s_lshl_b32 s72, s72, 7
  s_add_u32 s72, s72, 6422528
  s_lshl_b32 s70, s33, 1
  s_and_b32 s5, s61, 1
  s_add_u32 s70, s70, s5
  s_lshl_b32 s70, s70, 6
  s_lshr_b32 s5, s34, 3
  s_add_u32 s70, s70, s5
  s_lshl_b32 s70, s70, 7
  s_and_b32 s5, s34, 7
  s_lshl_b32 s5, s5, 3
  s_add_u32 s70, s70, s5
  s_lshr_b32 s5, s61, 1
  s_lshl_b32 s5, s5, 2
  s_add_u32 s70, s70, s5
  s_add_u32 s70, s70, 6422528
  v_lshlrev_b32 v126, 7, v1
  v_lshlrev_b32 v127, 9, v1
  v_lshlrev_b32 v9, 2, v12
  v_bfe_u32 v34, v1, 2, 2
  v_lshl_add_u32 v35, v15, 2, v33
  v_bfe_u32 v36, v1, 1, 2
  v_and_b32 v37, 1, v1
  v_add_u32 v37, 12, v37
  v_cmp_gt_u32 vcc, 48, v1
  s_mul_i32 s3, s61, 100352
  s_mul_i32 s5, s54, 224
  s_add_u32 s3, s3, s5
  v_cndmask_b32 v34, v36, v34, vcc
  v_cndmask_b32 v35, v37, v35, vcc
  v_mul_u32_u24 v8, 896, v34
  v_lshl_add_u32 v8, v35, 4, v8
  v_add_u32 v8, s3, v8
  s_mul_i32 s73, s61, 25088
  s_lshl_b32 s74, s66, 12
  s_add_u32 s75, s74, 8388608
  v_and_b32 v33, 1, v15
  v_lshrrev_b32 v34, 1, v15
  v_lshlrev_b32 v35, 5, v13
  v_lshl_add_u32 v35, v33, 4, v35
  v_lshl_add_u32 v35, v34, 9, v35
  v_add_u32 v73, s62, v35
  v_lshlrev_b32 v35, 4, v13
  v_lshrrev_b32 v35, v34, v35
  v_lshl_add_u32 v35, v15, 8, v35
  s_add_u32 s3, s62, 1024
  v_add_u32 v74, s3, v35
  v_mul_u32_u24 v35, 120, v34
  v_add3_u32 v75, v74, v35, 8
  v_lshlrev_b32 v35, 2, v13
  v_lshl_add_u32 v35, v15, 8, v35
  s_add_u32 s3, s62, 2048
  v_add_u32 v10, s3, v35
  s_and_b32 s3, s61, 2
  s_mul_i32 s76, s3, 8448
  s_add_u32 s76, s76, 110592
  s_movk_i32 s77, 0x4280
  s_movk_i32 s78, 128
  v_and_b32 v33, 127, v0
  v_lshlrev_b32 v33, 4, v33
  v_sub_u32 v33, 2047, v33
  v_cvt_f32_u32 v34, v33
  v_subrev_f32 v35, 0x0, v34
  v_subrev_f32 v36, 0x3f800000, v34
  v_cvt_pk_bf16_f32 v35, v35, v36
  v_lshrrev_b32 v36, 16, v35
  v_and_b32 v35, 0xffff, v35
  v_subrev_u32 v35, s77, v35
  v_subrev_u32 v37, 0, v33
  v_med3_i32 v35, v35, v37, s78
  v_lshl_add_u32 v16, v35, 2, s76
  v_subrev_u32 v36, s77, v36
  v_subrev_u32 v37, 1, v33
  v_med3_i32 v36, v36, v37, s78
  v_lshl_add_u32 v17, v36, 2, s76
  v_subrev_f32 v35, 0x40000000, v34
  v_subrev_f32 v36, 0x40400000, v34
  v_cvt_pk_bf16_f32 v35, v35, v36
  v_lshrrev_b32 v36, 16, v35
  v_and_b32 v35, 0xffff, v35
  v_subrev_u32 v35, s77, v35
  v_subrev_u32 v37, 2, v33
  v_med3_i32 v35, v35, v37, s78
  v_lshl_add_u32 v18, v35, 2, s76
  v_subrev_u32 v36, s77, v36
  v_subrev_u32 v37, 3, v33
  v_med3_i32 v36, v36, v37, s78
  v_lshl_add_u32 v19, v36, 2, s76
  v_subrev_f32 v35, 0x40800000, v34
  v_subrev_f32 v36, 0x40a00000, v34
  v_cvt_pk_bf16_f32 v35, v35, v36
  v_lshrrev_b32 v36, 16, v35
  v_and_b32 v35, 0xffff, v35
  v_subrev_u32 v35, s77, v35
  v_subrev_u32 v37, 4, v33
  v_med3_i32 v35, v35, v37, s78
  v_lshl_add_u32 v20, v35, 2, s76
  v_subrev_u32 v36, s77, v36
  v_subrev_u32 v37, 5, v33
  v_med3_i32 v36, v36, v37, s78
  v_lshl_add_u32 v21, v36, 2, s76
  v_subrev_f32 v35, 0x40c00000, v34
  v_subrev_f32 v36, 0x40e00000, v34
  v_cvt_pk_bf16_f32 v35, v35, v36
  v_lshrrev_b32 v36, 16, v35
  v_and_b32 v35, 0xffff, v35
  v_subrev_u32 v35, s77, v35
  v_subrev_u32 v37, 6, v33
  v_med3_i32 v35, v35, v37, s78
  v_lshl_add_u32 v22, v35, 2, s76
  v_subrev_u32 v36, s77, v36
  v_subrev_u32 v37, 7, v33
  v_med3_i32 v36, v36, v37, s78
  v_lshl_add_u32 v23, v36, 2, s76
  v_subrev_f32 v35, 0x41000000, v34
  v_subrev_f32 v36, 0x41100000, v34
  v_cvt_pk_bf16_f32 v35, v35, v36
  v_lshrrev_b32 v36, 16, v35
  v_and_b32 v35, 0xffff, v35
  v_subrev_u32 v35, s77, v35
  v_subrev_u32 v37, 8, v33
  v_med3_i32 v35, v35, v37, s78
  v_lshl_add_u32 v24, v35, 2, s76
  v_subrev_u32 v36, s77, v36
  v_subrev_u32 v37, 9, v33
  v_med3_i32 v36, v36, v37, s78
  v_lshl_add_u32 v25, v36, 2, s76
  v_subrev_f32 v35, 0x41200000, v34
  v_subrev_f32 v36, 0x41300000, v34
  v_cvt_pk_bf16_f32 v35, v35, v36
  v_lshrrev_b32 v36, 16, v35
  v_and_b32 v35, 0xffff, v35
  v_subrev_u32 v35, s77, v35
  v_subrev_u32 v37, 10, v33
  v_med3_i32 v35, v35, v37, s78
  v_lshl_add_u32 v26, v35, 2, s76
  v_subrev_u32 v36, s77, v36
  v_subrev_u32 v37, 11, v33
  v_med3_i32 v36, v36, v37, s78
  v_lshl_add_u32 v27, v36, 2, s76
  v_subrev_f32 v35, 0x41400000, v34
  v_subrev_f32 v36, 0x41500000, v34
  v_cvt_pk_bf16_f32 v35, v35, v36
  v_lshrrev_b32 v36, 16, v35
  v_and_b32 v35, 0xffff, v35
  v_subrev_u32 v35, s77, v35
  v_subrev_u32 v37, 12, v33
  v_med3_i32 v35, v35, v37, s78
  v_lshl_add_u32 v28, v35, 2, s76
  v_subrev_u32 v36, s77, v36
  v_subrev_u32 v37, 13, v33
  v_med3_i32 v36, v36, v37, s78
  v_lshl_add_u32 v29, v36, 2, s76
  v_subrev_f32 v35, 0x41600000, v34
  v_subrev_f32 v36, 0x41700000, v34
  v_cvt_pk_bf16_f32 v35, v35, v36
  v_lshrrev_b32 v36, 16, v35
  v_and_b32 v35, 0xffff, v35
  v_subrev_u32 v35, s77, v35
  v_subrev_u32 v37, 14, v33
  v_med3_i32 v35, v35, v37, s78
  v_lshl_add_u32 v30, v35, 2, s76
  v_subrev_u32 v36, s77, v36
  v_subrev_u32 v37, 15, v33
  v_med3_i32 v36, v36, v37, s78
  v_lshl_add_u32 v31, v36, 2, s76
  v_subrev_f32 v35, 0x41800000, v34
  v_cvt_pk_bf16_f32 v35, v35, v36
  v_and_b32 v35, 0xffff, v35
  v_subrev_u32 v35, s77, v35
  v_subrev_u32 v37, 16, v33
  v_med3_i32 v35, v35, v37, s78
  v_lshl_add_u32 v32, v35, 2, s76
  s_waitcnt lgkmcnt(0)
  s_add_u32 s56, s60, 0x9E3779B1
  s_setprio 1
  s_barrier
  s_cmp_eq_u32 s33, 7
  s_cbranch_scc1 HSKIP
  s_waitcnt vmcnt(2)
  s_lshr_b32 s3, s32, 1
  s_and_b32 s3, s3, 1
  s_lshl_b32 s3, s3, 4
  s_lshr_b32 s6, s58, s3
  s_lshl_b32 s6, s6, 16
  s_lshr_b32 s59, s59, s3
  s_lshl_b32 s59, s59, 16
  v_mov_b32 v70, 0x3fb8aa3b
  v_mul_f32 v70, s6, v70
  v_exp_f32 v70, v70
  s_nop 0
  v_cvt_pk_bf16_f32 v70, v70, v70
  v_and_b32 v70, 0xffff0000, v70
  v_lshlrev_b32 v48, 16, v64
  v_and_b32 v56, 0xffff0000, v64
  v_lshlrev_b32 v49, 16, v65
  v_and_b32 v57, 0xffff0000, v65
  v_mul_f32 v48, v70, v48
  v_mul_f32 v56, v70, v56
  v_mul_f32 v49, v70, v49
  v_mul_f32 v57, v70, v57
  v_mul_f32 v48, 0x3fb8aa3b, v48
  v_mul_f32 v56, 0x3fb8aa3b, v56
  v_mul_f32 v49, 0x3e22f983, v49
  v_mul_f32 v57, 0x3e22f983, v57
  v_mul_f32 v50, 0x41000000, v48
  v_mul_f32 v58, 0x41000000, v56
  v_mul_f32 v52, 0x41000000, v49
  v_mul_f32 v60, 0x41000000, v57
  v_exp_f32 v50, v50
  v_exp_f32 v58, v58
  v_fract_f32 v52, v52
  v_fract_f32 v60, v60
  v_cos_f32 v84, v52
  v_cos_f32 v104, v60
  v_sin_f32 v85, v52
  v_sin_f32 v105, v60
  v_mul_f32 v84, v50, v84
  v_mul_f32 v104, v58, v104
  v_mul_f32 v85, v50, v85
  v_mul_f32 v105, v58, v105
  v_lshlrev_b32 v92, 16, v66
  v_and_b32 v112, 0xffff0000, v66
  v_lshlrev_b32 v93, 16, v67
  v_and_b32 v113, 0xffff0000, v67
  v_lshlrev_b32 v94, 16, v68
  v_and_b32 v114, 0xffff0000, v68
  v_lshlrev_b32 v95, 16, v69
  v_and_b32 v115, 0xffff0000, v69
  v_mul_f32 v92, v70, v92
  v_mul_f32 v112, v70, v112
  v_mul_f32 v93, v70, v93
  v_mul_f32 v113, v70, v113
  v_mul_f32 v88, v92, v94
  v_mul_f32 v108, v112, v114
  v_mul_f32 v89, v92, v95
  v_mul_f32 v109, v112, v115
  s_waitcnt vmcnt(0)
  ds_read_b64_tr_b16 a[64:65], v6 offset:0
  ds_read_b64_tr_b16 a[66:67], v6 offset:128
  ds_read_b64_tr_b16 a[68:69], v6 offset:1024
  ds_read_b64_tr_b16 a[70:71], v6 offset:1152
  v_fma_f32 v88, -v93, v95, v88
  v_fma_f32 v108, -v113, v115, v108
  v_fmac_f32 v89, v93, v94
  v_fmac_f32 v109, v113, v114
  v_cvt_pk_bf16_f32 v116, v88, -v89
  v_cvt_pk_bf16_f32 v117, v108, -v109
  v_mul_f32 v90, v88, v84
  v_mul_f32 v110, v108, v104
  v_mul_f32 v91, v88, v85
  v_mul_f32 v111, v108, v105
  v_fma_f32 v90, -v89, v85, v90
  v_fma_f32 v110, -v109, v105, v110
  v_fmac_f32 v91, v89, v84
  v_fmac_f32 v111, v109, v104
  v_cvt_pk_bf16_f32 v118, v90, -v91
  v_cvt_pk_bf16_f32 v119, v110, -v111
  v_mul_f32 v88, v90, v84
  v_mul_f32 v108, v110, v104
  v_mul_f32 v89, v90, v85
  v_mul_f32 v109, v110, v105
  s_setprio 3
  ds_write2_b64 v71, v[116:117], v[118:119] offset0:0 offset1:66
  s_setprio 1
  v_fma_f32 v88, -v91, v85, v88
  v_fma_f32 v108, -v111, v105, v108
  v_fmac_f32 v89, v91, v84
  s_waitcnt lgkmcnt(1)
  buffer_store_dwordx4 a[64:67], v7, s[24:27], 0 offen offset:0 sc1
  buffer_store_dwordx4 a[68:71], v7, s[24:27], 0 offen offset:64 sc1
  v_fmac_f32 v109, v111, v104
  v_cvt_pk_bf16_f32 v120, v88, -v89
  v_cvt_pk_bf16_f32 v121, v108, -v109
  v_mul_f32 v90, v88, v84
  v_mul_f32 v110, v108, v104
  v_mul_f32 v91, v88, v85
  v_mul_f32 v111, v108, v105
  v_fma_f32 v90, -v89, v85, v90
  v_fma_f32 v110, -v109, v105, v110
  v_fmac_f32 v91, v89, v84
  v_fmac_f32 v111, v109, v104
  v_cvt_pk_bf16_f32 v122, v90, -v91
  v_cvt_pk_bf16_f32 v123, v110, -v111
  v_mul_f32 v88, v90, v84
  v_mul_f32 v108, v110, v104
  v_mul_f32 v89, v90, v85
  v_mul_f32 v109, v110, v105
  s_setprio 3
  ds_write2_b64 v71, v[120:121], v[122:123] offset0:132 offset1:198
  s_setprio 1
  v_fma_f32 v88, -v91, v85, v88
  v_fma_f32 v108, -v111, v105, v108
  v_fmac_f32 v89, v91, v84
  v_fmac_f32 v109, v111, v104
  v_cvt_pk_bf16_f32 v116, v88, -v89
  v_cvt_pk_bf16_f32 v117, v108, -v109
  v_mul_f32 v90, v88, v84
  v_mul_f32 v110, v108, v104
  v_mul_f32 v91, v88, v85
  v_mul_f32 v111, v108, v105
  v_fma_f32 v90, -v89, v85, v90
  v_fma_f32 v110, -v109, v105, v110
  v_fmac_f32 v91, v89, v84
  v_fmac_f32 v111, v109, v104
  v_cvt_pk_bf16_f32 v118, v90, -v91
  v_cvt_pk_bf16_f32 v119, v110, -v111
  v_mul_f32 v88, v90, v84
  v_mul_f32 v108, v110, v104
  v_mul_f32 v89, v90, v85
  v_mul_f32 v109, v110, v105
  s_setprio 3
  ds_write2_b64 v42, v[116:117], v[118:119] offset0:0 offset1:66
  s_setprio 1
  v_fma_f32 v88, -v91, v85, v88
  v_fma_f32 v108, -v111, v105, v108
  v_fmac_f32 v89, v91, v84
  v_fmac_f32 v109, v111, v104
  v_cvt_pk_bf16_f32 v120, v88, -v89
  v_cvt_pk_bf16_f32 v121, v108, -v109
  v_mul_f32 v90, v88, v84
  v_mul_f32 v110, v108, v104
  v_mul_f32 v91, v88, v85
  v_mul_f32 v111, v108, v105
  v_fma_f32 v90, -v89, v85, v90
  v_fma_f32 v110, -v109, v105, v110
  v_fmac_f32 v91, v89, v84
  v_fmac_f32 v111, v109, v104
  v_cvt_pk_bf16_f32 v122, v90, -v91
  v_cvt_pk_bf16_f32 v123, v110, -v111
  v_mul_f32 v88, v90, v84
  v_mul_f32 v108, v110, v104
  v_mul_f32 v89, v90, v85
  v_mul_f32 v109, v110, v105
  s_setprio 3
  ds_write2_b64 v42, v[120:121], v[122:123] offset0:132 offset1:198
  s_setprio 1
  v_fma_f32 v88, -v91, v85, v88
  v_fma_f32 v108, -v111, v105, v108
  v_fmac_f32 v89, v91, v84
  v_fmac_f32 v109, v111, v104
  v_cvt_pk_bf16_f32 v116, v88, -v89
  v_cvt_pk_bf16_f32 v117, v108, -v109
  v_mul_f32 v90, v88, v84
  v_mul_f32 v110, v108, v104
  v_mul_f32 v91, v88, v85
  v_mul_f32 v111, v108, v105
  v_fma_f32 v90, -v89, v85, v90
  v_fma_f32 v110, -v109, v105, v110
  v_fmac_f32 v91, v89, v84
  v_fmac_f32 v111, v109, v104
  v_cvt_pk_bf16_f32 v118, v90, -v91
  v_cvt_pk_bf16_f32 v119, v110, -v111
  v_mul_f32 v88, v90, v84
  v_mul_f32 v108, v110, v104
  v_mul_f32 v89, v90, v85
  v_mul_f32 v109, v110, v105
  s_setprio 3
  ds_write2_b64 v43, v[116:117], v[118:119] offset0:0 offset1:66
  s_setprio 1
  v_fma_f32 v88, -v91, v85, v88
  v_fma_f32 v108, -v111, v105, v108
  v_fmac_f32 v89, v91, v84
  v_fmac_f32 v109, v111, v104
  v_cvt_pk_bf16_f32 v120, v88, -v89
  v_cvt_pk_bf16_f32 v121, v108, -v109
  v_mul_f32 v90, v88, v84
  v_mul_f32 v110, v108, v104
  v_mul_f32 v91, v88, v85
  v_mul_f32 v111, v108, v105
  v_fma_f32 v90, -v89, v85, v90
  v_fma_f32 v110, -v109, v105, v110
  v_fmac_f32 v91, v89, v84
  v_fmac_f32 v111, v109, v104
  v_cvt_pk_bf16_f32 v122, v90, -v91
  v_cvt_pk_bf16_f32 v123, v110, -v111
  v_mul_f32 v88, v90, v84
  v_mul_f32 v108, v110, v104
  v_mul_f32 v89, v90, v85
  v_mul_f32 v109, v110, v105
  s_setprio 3
  ds_write2_b64 v43, v[120:121], v[122:123] offset0:132 offset1:198
  s_setprio 1
  v_fma_f32 v88, -v91, v85, v88
  v_fma_f32 v108, -v111, v105, v108
  v_fmac_f32 v89, v91, v84
  v_fmac_f32 v109, v111, v104
  v_cvt_pk_bf16_f32 v116, v88, -v89
  v_cvt_pk_bf16_f32 v117, v108, -v109
  v_mul_f32 v90, v88, v84
  v_mul_f32 v110, v108, v104
  v_mul_f32 v91, v88, v85
  v_mul_f32 v111, v108, v105
  v_fma_f32 v90, -v89, v85, v90
  v_fma_f32 v110, -v109, v105, v110
  v_fmac_f32 v91, v89, v84
  v_fmac_f32 v111, v109, v104
  v_cvt_pk_bf16_f32 v118, v90, -v91
  v_cvt_pk_bf16_f32 v119, v110, -v111
  v_mul_f32 v88, v90, v84
  v_mul_f32 v108, v110, v104
  v_mul_f32 v89, v90, v85
  v_mul_f32 v109, v110, v105
  s_setprio 3
  ds_write2_b64 v44, v[116:117], v[118:119] offset0:0 offset1:66
  s_setprio 1
  v_fma_f32 v88, -v91, v85, v88
  v_fma_f32 v108, -v111, v105, v108
  v_fmac_f32 v89, v91, v84
  v_fmac_f32 v109, v111, v104
  v_cvt_pk_bf16_f32 v120, v88, -v89
  v_cvt_pk_bf16_f32 v121, v108, -v109
  v_mul_f32 v90, v88, v84
  v_mul_f32 v110, v108, v104
  v_mul_f32 v91, v88, v85
  v_mul_f32 v111, v108, v105
  v_fma_f32 v90, -v89, v85, v90
  v_fma_f32 v110, -v109, v105, v110
  v_fmac_f32 v91, v89, v84
  v_fmac_f32 v111, v109, v104
  v_cvt_pk_bf16_f32 v122, v90, -v91
  v_cvt_pk_bf16_f32 v123, v110, -v111
  s_setprio 3
  ds_write2_b64 v44, v[120:121], v[122:123] offset0:132 offset1:198
  ds_read_b128 a[0:3], v72 offset:0
  ds_read_b128 a[4:7], v72 offset:64
  ds_read_b128 a[8:11], v72 offset:128
  ds_read_b128 a[12:15], v72 offset:192
  ds_read_b128 a[16:19], v72 offset:256
  ds_read_b128 a[20:23], v72 offset:320
  ds_read_b128 a[24:27], v72 offset:384
  ds_read_b128 a[28:31], v72 offset:448
  s_setprio 1
  v_exp_f32 v50, v48
  v_exp_f32 v58, v56
  v_fract_f32 v52, v49
  v_fract_f32 v60, v57
  v_cos_f32 v76, v52
  v_cos_f32 v96, v60
  v_sin_f32 v77, v52
  v_sin_f32 v97, v60
  v_mul_f32 v76, v50, v76
  v_mul_f32 v96, v58, v96
  v_mul_f32 v77, v50, v77
  v_mul_f32 v97, v58, v97
  v_mul_f32 v50, 0x43000000, v48
  v_mul_f32 v58, 0x43000000, v56
  v_mul_f32 v52, 0x43000000, v49
  v_mul_f32 v60, 0x43000000, v57
  v_exp_f32 v50, v50
  v_exp_f32 v58, v58
  v_fract_f32 v52, v52
  v_fract_f32 v60, v60
  v_cos_f32 v86, v52
  v_cos_f32 v106, v60
  v_sin_f32 v87, v52
  v_sin_f32 v107, v60
  v_mul_f32 v86, v50, v86
  v_mul_f32 v106, v58, v106
  v_mul_f32 v87, v50, v87
  v_mul_f32 v107, v58, v107
  v_mov_b32 v116, 0x3f80
  v_mov_b32 v117, 0x3f80
  v_cvt_pk_bf16_f32 v118, v76, v77
  v_cvt_pk_bf16_f32 v119, v96, v97
  v_cvt_pk_bf16_f32 v120, v86, v87
  v_cvt_pk_bf16_f32 v121, v106, v107
  v_mul_f32 v92, v86, v76
  v_mul_f32 v112, v106, v96
  s_setprio 3
  ds_write2_b64 v71, v[116:117], v[118:119] offset0:0 offset1:66
  s_setprio 1
  v_mul_f32 v93, v86, v77
  v_mul_f32 v113, v106, v97
  v_fma_f32 v92, -v87, v77, v92
  v_fma_f32 v112, -v107, v97, v112
  v_fmac_f32 v93, v87, v76
  v_fmac_f32 v113, v107, v96
  v_cvt_pk_bf16_f32 v122, v92, v93
  v_cvt_pk_bf16_f32 v123, v112, v113
  v_mul_f32 v78, v76, v76
  v_mul_f32 v98, v96, v96
  v_mul_f32 v79, v76, v77
  v_mul_f32 v99, v96, v97
  s_setprio 3
  ds_write2_b64 v43, v[120:121], v[122:123] offset0:0 offset1:66
  s_setprio 1
  v_fma_f32 v78, -v77, v77, v78
  v_fma_f32 v98, -v97, v97, v98
  v_fmac_f32 v79, v77, v76
  v_fmac_f32 v99, v97, v96
  v_cvt_pk_bf16_f32 v116, v78, v79
  v_cvt_pk_bf16_f32 v117, v98, v99
  v_mul_f32 v92, v86, v78
  v_mul_f32 v112, v106, v98
  v_mul_f32 v93, v86, v79
  v_mul_f32 v113, v106, v99
  v_fma_f32 v92, -v87, v79, v92
  v_fma_f32 v112, -v107, v99, v112
  v_fmac_f32 v93, v87, v78
  v_fmac_f32 v113, v107, v98
  v_cvt_pk_bf16_f32 v118, v92, v93
  v_cvt_pk_bf16_f32 v119, v112, v113
  s_setprio 3
  ds_write_b64 v71, v[116:117] offset:1056
  s_setprio 1
  v_mul_f32 v94, v78, v76
  v_mul_f32 v114, v98, v96
  v_mul_f32 v95, v78, v77
  v_mul_f32 v115, v98, v97
  v_fma_f32 v94, -v79, v77, v94
  v_fma_f32 v114, -v99, v97, v114
  v_fmac_f32 v95, v79, v76
  v_fmac_f32 v115, v99, v96
  v_cvt_pk_bf16_f32 v120, v94, v95
  v_cvt_pk_bf16_f32 v121, v114, v115
  s_setprio 3
  ds_write_b64 v71, v[118:119] offset:5280
  s_setprio 1
  v_mul_f32 v92, v86, v94
  v_mul_f32 v112, v106, v114
  v_mul_f32 v93, v86, v95
  v_mul_f32 v113, v106, v115
  v_fma_f32 v92, -v87, v95, v92
  v_fma_f32 v112, -v107, v115, v112
  v_fmac_f32 v93, v87, v94
  v_fmac_f32 v113, v107, v114
  v_cvt_pk_bf16_f32 v122, v92, v93
  v_cvt_pk_bf16_f32 v123, v112, v113
  s_setprio 3
  ds_write_b64 v71, v[120:121] offset:1584
  s_setprio 1
  v_mul_f32 v80, v78, v78
  v_mul_f32 v100, v98, v98
  v_mul_f32 v81, v78, v79
  v_mul_f32 v101, v98, v99
  v_fma_f32 v80, -v79, v79, v80
  v_fma_f32 v100, -v99, v99, v100
  v_fmac_f32 v81, v79, v78
  v_fmac_f32 v101, v99, v98
  v_cvt_pk_bf16_f32 v116, v80, v81
  v_cvt_pk_bf16_f32 v117, v100, v101
  s_setprio 3
  ds_write_b64 v71, v[122:123] offset:5808
  s_setprio 1
  v_mul_f32 v92, v86, v80
  v_mul_f32 v112, v106, v100
  v_mul_f32 v93, v86, v81
  v_mul_f32 v113, v106, v101
  v_fma_f32 v92, -v87, v81, v92
  v_fma_f32 v112, -v107, v101, v112
  v_fmac_f32 v93, v87, v80
  v_fmac_f32 v113, v107, v100
  v_cvt_pk_bf16_f32 v118, v92, v93
  v_cvt_pk_bf16_f32 v119, v112, v113
  s_setprio 3
  ds_write_b64 v71, v[116:117] offset:2112
  s_setprio 1
  v_mul_f32 v94, v80, v76
  v_mul_f32 v114, v100, v96
  v_mul_f32 v95, v80, v77
  v_mul_f32 v115, v100, v97
  v_fma_f32 v94, -v81, v77, v94
  v_fma_f32 v114, -v101, v97, v114
  v_fmac_f32 v95, v81, v76
  v_fmac_f32 v115, v101, v96
  v_cvt_pk_bf16_f32 v120, v94, v95
  v_cvt_pk_bf16_f32 v121, v114, v115
  s_setprio 3
  ds_write_b64 v71, v[118:119] offset:6336
  s_setprio 1
  v_mul_f32 v92, v86, v94
  v_mul_f32 v112, v106, v114
  v_mul_f32 v93, v86, v95
  v_mul_f32 v113, v106, v115
  v_fma_f32 v92, -v87, v95, v92
  v_fma_f32 v112, -v107, v115, v112
  v_fmac_f32 v93, v87, v94
  v_fmac_f32 v113, v107, v114
  v_cvt_pk_bf16_f32 v122, v92, v93
  s_waitcnt vmcnt(0)
  v_mov_b32 v45, s56
  s_mov_b64 exec, 0xff
  buffer_store_dword v45, v126, s[24:27], s69 offen sc1
  s_mov_b64 exec, -1
  v_cvt_pk_bf16_f32 v123, v112, v113
  s_setprio 3
  ds_write_b64 v71, v[120:121] offset:2640
  s_setprio 1
  v_mul_f32 v82, v80, v78
  v_mul_f32 v102, v100, v98
  v_mul_f32 v83, v80, v79
  v_mul_f32 v103, v100, v99
  v_fma_f32 v82, -v81, v79, v82
  v_fma_f32 v102, -v101, v99, v102
  v_fmac_f32 v83, v81, v78
  v_fmac_f32 v103, v101, v98
  v_cvt_pk_bf16_f32 v116, v82, v83
  v_cvt_pk_bf16_f32 v117, v102, v103
  s_setprio 3
  ds_write_b64 v71, v[122:123] offset:6864
  s_setprio 1
  v_mul_f32 v92, v86, v82
  v_mul_f32 v112, v106, v102
  v_mul_f32 v93, v86, v83
  v_mul_f32 v113, v106, v103
  v_fma_f32 v92, -v87, v83, v92
  v_fma_f32 v112, -v107, v103, v112
  v_fmac_f32 v93, v87, v82
  v_fmac_f32 v113, v107, v102
  v_cvt_pk_bf16_f32 v118, v92, v93
  v_cvt_pk_bf16_f32 v119, v112, v113
  s_setprio 3
  ds_write_b64 v71, v[116:117] offset:3168
  s_setprio 1
  v_mul_f32 v94, v82, v76
  v_mul_f32 v114, v102, v96
  v_mul_f32 v95, v82, v77
  v_mul_f32 v115, v102, v97
  v_fma_f32 v94, -v83, v77, v94
  v_fma_f32 v114, -v103, v97, v114
  v_fmac_f32 v95, v83, v76
  v_fmac_f32 v115, v103, v96
  v_cvt_pk_bf16_f32 v120, v94, v95
  v_cvt_pk_bf16_f32 v121, v114, v115
  s_setprio 3
  ds_write_b64 v71, v[118:119] offset:7392
  s_setprio 1
  v_mul_f32 v92, v86, v94
  v_mul_f32 v112, v106, v114
  v_mul_f32 v93, v86, v95
  v_mul_f32 v113, v106, v115
  v_fma_f32 v92, -v87, v95, v92
  v_fma_f32 v112, -v107, v115, v112
  v_fmac_f32 v93, v87, v94
  v_fmac_f32 v113, v107, v114
  v_cvt_pk_bf16_f32 v122, v92, v93
  v_cvt_pk_bf16_f32 v123, v112, v113
  s_setprio 3
  ds_write_b64 v71, v[120:121] offset:3696
  ds_write_b64 v71, v[122:123] offset:7920
  ds_read_b128 a[32:35], v72 offset:0
  ds_read_b128 a[36:39], v72 offset:64
  ds_read_b128 a[40:43], v72 offset:128
  ds_read_b128 a[44:47], v72 offset:192
  ds_read_b128 a[48:51], v72 offset:256
  ds_read_b128 a[52:55], v72 offset:320
  ds_read_b128 a[56:59], v72 offset:384
  ds_read_b128 a[60:63], v72 offset:448
  s_setprio 1
  v_mul_f32 v88, v86, v86
  v_mul_f32 v108, v106, v106
  v_mul_f32 v89, v86, v87
  v_mul_f32 v109, v106, v107
  v_fma_f32 v88, -v87, v87, v88
  v_fma_f32 v108, -v107, v107, v108
  v_fmac_f32 v89, v87, v86
  v_fmac_f32 v109, v107, v106
  v_cvt_pk_bf16_f32 v116, v88, v89
  v_cvt_pk_bf16_f32 v117, v108, v109
  v_mul_f32 v92, v88, v78
  v_mul_f32 v112, v108, v98
  v_mul_f32 v93, v88, v79
  v_mul_f32 v113, v108, v99
  v_fma_f32 v92, -v89, v79, v92
  v_fma_f32 v112, -v109, v99, v112
  v_fmac_f32 v93, v89, v78
  v_fmac_f32 v113, v109, v98
  v_cvt_pk_bf16_f32 v118, v92, v93
  v_cvt_pk_bf16_f32 v119, v112, v113
  v_mul_f32 v92, v88, v80
  v_mul_f32 v112, v108, v100
  v_mul_f32 v93, v88, v81
  v_mul_f32 v113, v108, v101
  s_setprio 3
  ds_write2_b64 v71, v[116:117], v[118:119] offset0:0 offset1:66
  s_setprio 1
  s_waitcnt lgkmcnt(1)
  v_mfma_f32_16x16x32_bf16 a[96:99], a[32:35], a[0:3], 0
  v_fma_f32 v92, -v89, v81, v92
  v_fma_f32 v112, -v109, v101, v112
  v_fmac_f32 v93, v89, v80
  v_fmac_f32 v113, v109, v100
  v_mfma_f32_16x16x32_bf16 a[96:99], a[36:39], a[4:7], a[96:99]
  v_cvt_pk_bf16_f32 v120, v92, v93
  v_cvt_pk_bf16_f32 v121, v112, v113
  v_mul_f32 v92, v88, v82
  v_mul_f32 v112, v108, v102
  v_mfma_f32_16x16x32_bf16 a[96:99], a[40:43], a[8:11], a[96:99]
  v_mul_f32 v93, v88, v83
  v_mul_f32 v113, v108, v103
  v_fma_f32 v92, -v89, v83, v92
  v_fma_f32 v112, -v109, v103, v112
  v_mfma_f32_16x16x32_bf16 a[96:99], a[44:47], a[12:15], a[96:99]
  v_fmac_f32 v93, v89, v82
  v_fmac_f32 v113, v109, v102
  v_cvt_pk_bf16_f32 v122, v92, v93
  v_cvt_pk_bf16_f32 v123, v112, v113
  v_mfma_f32_16x16x32_bf16 a[96:99], a[48:51], a[16:19], a[96:99]
  v_mul_f32 v90, v88, v86
  v_mul_f32 v110, v108, v106
  v_mul_f32 v91, v88, v87
  v_mul_f32 v111, v108, v107
  s_setprio 3
  ds_write2_b64 v71, v[120:121], v[122:123] offset0:132 offset1:198
  s_setprio 1
  v_mfma_f32_16x16x32_bf16 a[96:99], a[52:55], a[20:23], a[96:99]
  v_fma_f32 v90, -v89, v87, v90
  v_fma_f32 v110, -v109, v107, v110
  v_fmac_f32 v91, v89, v86
  v_fmac_f32 v111, v109, v106
  v_mfma_f32_16x16x32_bf16 a[96:99], a[56:59], a[24:27], a[96:99]
  v_cvt_pk_bf16_f32 v116, v90, v91
  v_cvt_pk_bf16_f32 v117, v110, v111
  v_mul_f32 v92, v90, v78
  v_mul_f32 v112, v110, v98
  v_mfma_f32_16x16x32_bf16 a[96:99], a[60:63], a[28:31], a[96:99]
  v_mul_f32 v93, v90, v79
  v_mul_f32 v113, v110, v99
  v_fma_f32 v92, -v91, v79, v92
  v_fma_f32 v112, -v111, v99, v112
  v_fmac_f32 v93, v91, v78
  v_fmac_f32 v113, v111, v98
  v_cvt_pk_bf16_f32 v118, v92, v93
  v_cvt_pk_bf16_f32 v119, v112, v113
  v_mul_f32 v92, v90, v80
  v_mul_f32 v112, v110, v100
  v_mul_f32 v93, v90, v81
  v_mul_f32 v113, v110, v101
  s_setprio 3
  ds_write2_b64 v42, v[116:117], v[118:119] offset0:0 offset1:66
  s_setprio 1
  v_fma_f32 v92, -v91, v81, v92
  v_fma_f32 v112, -v111, v101, v112
  v_fmac_f32 v93, v91, v80
  v_fmac_f32 v113, v111, v100
  v_cvt_pk_bf16_f32 v120, v92, v93
  v_cvt_pk_bf16_f32 v121, v112, v113
  v_mul_f32 v92, v90, v82
  v_mul_f32 v112, v110, v102
  v_mul_f32 v93, v90, v83
  v_mul_f32 v113, v110, v103
  v_fma_f32 v92, -v91, v83, v92
  v_fma_f32 v112, -v111, v103, v112
  v_fmac_f32 v93, v91, v82
  v_fmac_f32 v113, v111, v102
  v_cvt_pk_bf16_f32 v122, v92, v93
  v_cvt_pk_bf16_f32 v123, v112, v113
  v_mul_f32 v88, v90, v86
  v_mul_f32 v108, v110, v106
  v_mul_f32 v89, v90, v87
  v_mul_f32 v109, v110, v107
  s_setprio 3
  ds_write2_b64 v42, v[120:121], v[122:123] offset0:132 offset1:198
  s_setprio 1
  v_fma_f32 v88, -v91, v87, v88
  v_fma_f32 v108, -v111, v107, v108
  v_fmac_f32 v89, v91, v86
  v_fmac_f32 v109, v111, v106
  v_cvt_pk_bf16_f32 v116, v88, v89
  v_cvt_pk_bf16_f32 v117, v108, v109
  v_mul_f32 v92, v88, v80
  v_mul_f32 v112, v108, v100
  v_mul_f32 v93, v88, v81
  v_mul_f32 v113, v108, v101
  v_fma_f32 v92, -v89, v81, v92
  v_fma_f32 v112, -v109, v101, v112
  v_fmac_f32 v93, v89, v80
  v_fmac_f32 v113, v109, v100
  v_cvt_pk_bf16_f32 v118, v92, v93
  v_cvt_pk_bf16_f32 v119, v112, v113
  v_mul_f32 v90, v88, v86
  v_mul_f32 v110, v108, v106
  v_mul_f32 v91, v88, v87
  v_mul_f32 v111, v108, v107
  s_setprio 3
  ds_write2_b64 v43, v[116:117], v[118:119] offset0:0 offset1:66
  s_setprio 1
  v_fma_f32 v90, -v89, v87, v90
  v_fma_f32 v110, -v109, v107, v110
  v_fmac_f32 v91, v89, v86
  v_fmac_f32 v111, v109, v106
  v_cvt_pk_bf16_f32 v120, v90, v91
  v_cvt_pk_bf16_f32 v121, v110, v111
  v_mul_f32 v92, v90, v80
  v_mul_f32 v112, v110, v100
  v_mul_f32 v93, v90, v81
  v_mul_f32 v113, v110, v101
  v_fma_f32 v92, -v91, v81, v92
  v_fma_f32 v112, -v111, v101, v112
  v_fmac_f32 v93, v91, v80
  v_fmac_f32 v113, v111, v100
  v_cvt_pk_bf16_f32 v122, v92, v93
  v_cvt_pk_bf16_f32 v123, v112, v113
  v_mul_f32 v88, v90, v86
  v_mul_f32 v108, v110, v106
  v_mul_f32 v89, v90, v87
  v_mul_f32 v109, v110, v107
  s_setprio 3
  ds_write2_b64 v43, v[120:121], v[122:123] offset0:132 offset1:198
  s_setprio 1
  v_fma_f32 v88, -v91, v87, v88
  v_fma_f32 v108, -v111, v107, v108
  v_fmac_f32 v89, v91, v86
  v_fmac_f32 v109, v111, v106
  v_cvt_pk_bf16_f32 v116, v88, v89
  v_cvt_pk_bf16_f32 v117, v108, v109
  v_mul_f32 v92, v88, v80
  v_mul_f32 v112, v108, v100
  v_mul_f32 v93, v88, v81
  v_mul_f32 v113, v108, v101
  v_fma_f32 v92, -v89, v81, v92
  v_fma_f32 v112, -v109, v101, v112
  v_fmac_f32 v93, v89, v80
  v_fmac_f32 v113, v109, v100
  v_cvt_pk_bf16_f32 v118, v92, v93
  v_cvt_pk_bf16_f32 v119, v112, v113
  v_mul_f32 v90, v88, v86
  v_mul_f32 v110, v108, v106
  v_mul_f32 v91, v88, v87
  v_mul_f32 v111, v108, v107
  s_setprio 3
  ds_write2_b64 v44, v[116:117], v[118:119] offset0:0 offset1:66
  s_setprio 1
  v_fma_f32 v90, -v89, v87, v90
  v_fma_f32 v110, -v109, v107, v110
  v_fmac_f32 v91, v89, v86
  v_fmac_f32 v111, v109, v106
  v_cvt_pk_bf16_f32 v120, v90, v91
  v_cvt_pk_bf16_f32 v121, v110, v111
  v_mul_f32 v92, v90, v80
  v_mul_f32 v112, v110, v100
  v_mul_f32 v93, v90, v81
  v_mul_f32 v113, v110, v101
  v_fma_f32 v92, -v91, v81, v92
  v_fma_f32 v112, -v111, v101, v112
  v_fmac_f32 v93, v91, v80
  v_fmac_f32 v113, v111, v100
  v_cvt_pk_bf16_f32 v122, v92, v93
  v_cvt_pk_bf16_f32 v123, v112, v113
  s_setprio 3
  ds_write2_b64 v44, v[120:121], v[122:123] offset0:132 offset1:198
  ds_read_b128 a[32:35], v72 offset:0
  ds_read_b128 a[36:39], v72 offset:64
  ds_read_b128 a[40:43], v72 offset:128
  ds_read_b128 a[44:47], v72 offset:192
  ds_read_b128 a[48:51], v72 offset:256
  ds_read_b128 a[52:55], v72 offset:320
  ds_read_b128 a[56:59], v72 offset:384
  ds_read_b128 a[60:63], v72 offset:448
  s_setprio 1
  v_mul_f32 v88, v90, v86
  v_mul_f32 v108, v110, v106
  v_mul_f32 v89, v90, v87
  v_mul_f32 v109, v110, v107
  v_fma_f32 v88, -v91, v87, v88
  v_fma_f32 v108, -v111, v107, v108
  v_fmac_f32 v89, v91, v86
  v_fmac_f32 v109, v111, v106
  v_cvt_pk_bf16_f32 v116, v88, v89
  v_cvt_pk_bf16_f32 v117, v108, v109
  v_mul_f32 v90, v88, v86
  v_mul_f32 v110, v108, v106
  v_mov_b32 v41, 0
  s_mov_b32 exec_hi, 0
  buffer_atomic_or v41, v9, s[24:27], s71 offen sc0 sc1
  s_mov_b64 exec, -1
  v_mul_f32 v91, v88, v87
  v_mul_f32 v111, v108, v107
  v_fma_f32 v90, -v89, v87, v90
  v_fma_f32 v110, -v109, v107, v110
  v_fmac_f32 v91, v89, v86
  v_fmac_f32 v111, v109, v106
  v_cvt_pk_bf16_f32 v118, v90, v91
  v_cvt_pk_bf16_f32 v119, v110, v111
  v_mul_f32 v88, v90, v86
  v_mul_f32 v108, v110, v106
  v_mul_f32 v89, v90, v87
  v_mul_f32 v109, v110, v107
  s_setprio 3
  ds_write2_b64 v71, v[116:117], v[118:119] offset0:0 offset1:66
  s_setprio 1
  s_waitcnt lgkmcnt(1)
  v_mfma_f32_16x16x32_bf16 a[100:103], a[32:35], a[0:3], 0
  v_fma_f32 v88, -v91, v87, v88
  v_fma_f32 v108, -v111, v107, v108
  v_fmac_f32 v89, v91, v86
  v_fmac_f32 v109, v111, v106
  v_mfma_f32_16x16x32_bf16 a[100:103], a[36:39], a[4:7], a[100:103]
  v_cvt_pk_bf16_f32 v120, v88, v89
  v_cvt_pk_bf16_f32 v121, v108, v109
  v_mul_f32 v90, v88, v86
  v_mul_f32 v110, v108, v106
  v_mfma_f32_16x16x32_bf16 a[100:103], a[40:43], a[8:11], a[100:103]
  v_mul_f32 v91, v88, v87
  v_mul_f32 v111, v108, v107
  v_fma_f32 v90, -v89, v87, v90
  v_fma_f32 v110, -v109, v107, v110
  v_mfma_f32_16x16x32_bf16 a[100:103], a[44:47], a[12:15], a[100:103]
  v_fmac_f32 v91, v89, v86
  v_fmac_f32 v111, v109, v106
  v_cvt_pk_bf16_f32 v122, v90, v91
  v_cvt_pk_bf16_f32 v123, v110, v111
  v_mfma_f32_16x16x32_bf16 a[100:103], a[48:51], a[16:19], a[100:103]
  v_mul_f32 v88, v90, v86
  v_mul_f32 v108, v110, v106
  v_mul_f32 v89, v90, v87
  v_mul_f32 v109, v110, v107
  s_setprio 3
  ds_write2_b64 v71, v[120:121], v[122:123] offset0:132 offset1:198
  s_setprio 1
  v_mfma_f32_16x16x32_bf16 a[100:103], a[52:55], a[20:23], a[100:103]
  v_fma_f32 v88, -v91, v87, v88
  v_fma_f32 v108, -v111, v107, v108
  v_fmac_f32 v89, v91, v86
  v_fmac_f32 v109, v111, v106
  v_mfma_f32_16x16x32_bf16 a[100:103], a[56:59], a[24:27], a[100:103]
  v_cvt_pk_bf16_f32 v116, v88, v89
  v_cvt_pk_bf16_f32 v117, v108, v109
  v_mul_f32 v90, v88, v86
  v_mul_f32 v110, v108, v106
  v_mfma_f32_16x16x32_bf16 a[100:103], a[60:63], a[28:31], a[100:103]
  v_mul_f32 v91, v88, v87
  v_mul_f32 v111, v108, v107
  v_fma_f32 v90, -v89, v87, v90
  v_fma_f32 v110, -v109, v107, v110
  v_fmac_f32 v91, v89, v86
  v_fmac_f32 v111, v109, v106
  v_cvt_pk_bf16_f32 v118, v90, v91
  v_cvt_pk_bf16_f32 v119, v110, v111
  v_mul_f32 v88, v90, v86
  v_mul_f32 v108, v110, v106
  v_mul_f32 v89, v90, v87
  v_mul_f32 v109, v110, v107
  s_setprio 3
  ds_write2_b64 v42, v[116:117], v[118:119] offset0:0 offset1:66
  s_setprio 1
  v_fma_f32 v88, -v91, v87, v88
  v_fma_f32 v108, -v111, v107, v108
  v_fmac_f32 v89, v91, v86
  v_fmac_f32 v109, v111, v106
  v_cvt_pk_bf16_f32 v120, v88, v89
  v_cvt_pk_bf16_f32 v121, v108, v109
  v_mul_f32 v90, v88, v86
  v_mul_f32 v110, v108, v106
  v_mul_f32 v91, v88, v87
  v_mul_f32 v111, v108, v107
  v_fma_f32 v90, -v89, v87, v90
  v_fma_f32 v110, -v109, v107, v110
  v_fmac_f32 v91, v89, v86
  v_fmac_f32 v111, v109, v106
  v_cvt_pk_bf16_f32 v122, v90, v91
  v_cvt_pk_bf16_f32 v123, v110, v111
  v_mul_f32 v88, v90, v86
  v_mul_f32 v108, v110, v106
  v_mul_f32 v89, v90, v87
  v_mul_f32 v109, v110, v107
  s_setprio 3
  ds_write2_b64 v42, v[120:121], v[122:123] offset0:132 offset1:198
  s_setprio 1
  v_fma_f32 v88, -v91, v87, v88
  v_fma_f32 v108, -v111, v107, v108
  v_fmac_f32 v89, v91, v86
  v_fmac_f32 v109, v111, v106
  v_cvt_pk_bf16_f32 v116, v88, v89
  v_cvt_pk_bf16_f32 v117, v108, v109
  s_setprio 3
  ds_write_b64 v71, v[116:117] offset:4224
  ds_read_b128 a[32:35], v72 offset:0
  ds_read_b128 a[36:39], v72 offset:64
  ds_read_b128 a[40:43], v72 offset:128
  ds_read_b128 a[44:47], v72 offset:192
  ds_read_b128 a[48:51], v72 offset:256
  ds_read_b128 a[52:55], v72 offset:320
  ds_read_b128 a[56:59], v72 offset:384
  ds_read_b128 a[60:63], v72 offset:448
  s_setprio 1
  s_waitcnt lgkmcnt(0)
  v_mfma_f32_16x16x32_bf16 a[104:107], a[32:35], a[0:3], 0
  v_mfma_f32_16x16x32_bf16 a[104:107], a[36:39], a[4:7], a[104:107]
  v_mfma_f32_16x16x32_bf16 a[104:107], a[40:43], a[8:11], a[104:107]
  v_mfma_f32_16x16x32_bf16 a[104:107], a[44:47], a[12:15], a[104:107]
  v_mfma_f32_16x16x32_bf16 a[104:107], a[48:51], a[16:19], a[104:107]
  v_mfma_f32_16x16x32_bf16 a[104:107], a[52:55], a[20:23], a[104:107]
  v_mfma_f32_16x16x32_bf16 a[104:107], a[56:59], a[24:27], a[104:107]
  v_mfma_f32_16x16x32_bf16 a[104:107], a[60:63], a[28:31], a[104:107]
  s_setprio 3
  s_mov_b32 s85, 0x8000
  s_branch HPOLL1C
HPOLL1:
  v_mov_b32 v41, 0
  s_mov_b32 exec_hi, 0
  buffer_atomic_or v41, v9, s[24:27], s71 offen sc0 sc1
  s_mov_b64 exec, -1
HPOLL1C:
  s_waitcnt vmcnt(0)
  v_cmp_ne_u32 vcc, s56, v41
  s_and_b32 vcc_lo, vcc_lo, vcc_lo
  s_cbranch_scc0 HPOLL1D
  s_sleep 4
  s_sub_u32 s85, s85, 1
  s_cbranch_scc0 HPOLL1
HPOLL1D:
  buffer_load_dwordx4 a[64:67], v2, s[24:27], s75 offen offset:0 sc1
  buffer_load_dwordx4 a[68:71], v2, s[24:27], s75 offen offset:1024 sc1
  buffer_load_dwordx4 a[72:75], v2, s[24:27], s75 offen offset:2048 sc1
  buffer_load_dwordx4 a[76:79], v2, s[24:27], s75 offen offset:3072 sc1
  ds_write_b128 v73, a[96:99]
  ds_write_b64 v74, a[100:101]
  ds_write_b64 v75, a[102:103]
  ds_write2_b32 v10, a104, a105 offset0:0 offset1:16
  ds_write2_b32 v10, a106, a107 offset0:32 offset1:48
  v_and_b32 v34, 127, v0
  v_lshl_add_u32 v33, v34, 5, s79
  s_movk_i32 s78, 127
  v_cmp_ne_u32 s[82:83], s78, v34
  v_mov_b32 v36, 0
  v_mov_b32 v37, 0
  v_mov_b32 v38, 0
  v_mov_b32 v39, 0
  v_mov_b32 v34, s59
  s_and_b32 s77, s61, 1
  s_mul_i32 s77, s77, 4160
  s_add_u32 s77, s77, s79
  s_add_u32 s77, s77, 4096
  v_cndmask_b32 v34, v34, v36, s[82:83]
  v_and_b32 v35, 3, v1
  v_lshl_add_u32 v35, v35, 4, s77
  s_waitcnt lgkmcnt(0)
  v_mov_b32 v40, 1
  ds_write_b32 v4, v40
  s_mov_b32 s85, 0x40000
HPS2:
  ds_read_b32 v40, v5
  s_waitcnt lgkmcnt(0)
  v_readfirstlane_b32 s3, v40
  s_cmp_ge_u32 s3, 1
  s_cbranch_scc1 HPS2D
  s_sleep 1
  s_sub_u32 s85, s85, 1
  s_cbranch_scc0 HPS2
HPS2D:
  ds_read2st64_b32 v[76:77], v16 offset0:0 offset1:33
  ds_read2st64_b32 v[78:79], v17 offset0:0 offset1:33
  ds_read2st64_b32 v[80:81], v18 offset0:0 offset1:33
  ds_read2st64_b32 v[82:83], v19 offset0:0 offset1:33
  ds_read2st64_b32 v[84:85], v20 offset0:0 offset1:33
  ds_read2st64_b32 v[86:87], v21 offset0:0 offset1:33
  ds_read2st64_b32 v[88:89], v22 offset0:0 offset1:33
  ds_read2st64_b32 v[90:91], v23 offset0:0 offset1:33
  ds_read2st64_b32 v[92:93], v24 offset0:0 offset1:33
  ds_read2st64_b32 v[94:95], v25 offset0:0 offset1:33
  ds_read2st64_b32 v[96:97], v26 offset0:0 offset1:33
  ds_read2st64_b32 v[98:99], v27 offset0:0 offset1:33
  ds_read2st64_b32 v[100:101], v28 offset0:0 offset1:33
  ds_read2st64_b32 v[102:103], v29 offset0:0 offset1:33
  ds_read2st64_b32 v[104:105], v30 offset0:0 offset1:33
  ds_read2st64_b32 v[106:107], v31 offset0:0 offset1:33
  ds_read2st64_b32 v[108:109], v32 offset0:0 offset1:33
  ds_write_b128 v35, v[36:39]
  s_waitcnt lgkmcnt(14)
  v_add_f32 v76, v76, v77
  v_add_f32 v78, v78, v79
  v_add_f32 v80, v80, v81
  v_add_f32 v82, v82, v83
  s_waitcnt lgkmcnt(10)
  v_add_f32 v84, v84, v85
  v_add_f32 v86, v86, v87
  v_add_f32 v88, v88, v89
  v_add_f32 v90, v90, v91
  s_waitcnt lgkmcnt(6)
  v_add_f32 v92, v92, v93
  v_add_f32 v94, v94, v95
  v_add_f32 v96, v96, v97
  v_add_f32 v98, v98, v99
  s_waitcnt lgkmcnt(2)
  v_add_f32 v100, v100, v101
  v_add_f32 v102, v102, v103
  v_add_f32 v104, v104, v105
  v_add_f32 v106, v106, v107
  s_waitcnt lgkmcnt(1)
  v_add_f32 v108, v108, v109
  v_add_f32 v106, v106, v34
  v_cndmask_b32 v108, 0, v108, s[82:83]
  v_cvt_pk_bf16_f32 v110, v76, v78
  v_cvt_pk_bf16_f32 v111, v80, v82
  v_cvt_pk_bf16_f32 v112, v84, v86
  v_cvt_pk_bf16_f32 v113, v88, v90
  v_cvt_pk_bf16_f32 v114, v92, v94
  v_cvt_pk_bf16_f32 v115, v96, v98
  v_cvt_pk_bf16_f32 v116, v100, v102
  v_cvt_pk_bf16_f32 v117, v104, v106
  ds_write_b128 v33, v[110:113]
  ds_write_b128 v33, v[114:117] offset:16
  v_cvt_pk_bf16_f32 v118, v78, v80
  v_cvt_pk_bf16_f32 v119, v82, v84
  v_cvt_pk_bf16_f32 v120, v86, v88
  v_cvt_pk_bf16_f32 v121, v90, v92
  v_cvt_pk_bf16_f32 v122, v94, v96
  v_cvt_pk_bf16_f32 v123, v98, v100
  v_cvt_pk_bf16_f32 v124, v102, v104
  v_cvt_pk_bf16_f32 v125, v106, v108
  ds_write_b128 v33, v[118:121] offset:4160
  ds_write_b128 v33, v[122:125] offset:4176
  s_and_b32 s77, s61, 1
  s_mul_i32 s78, s77, 320
  s_sub_u32 s78, s62, s78
  s_add_u32 s78, s78, 400
  v_mul_u32_u24 v96, 80, v12
  v_lshl_add_u32 v96, v11, 4, v96
  v_add_u32 v96, s78, v96
  s_lshl_b32 s77, s77, 8
  s_sub_u32 s77, s79, s77
  s_add_u32 s77, s77, 7740
  v_and_b32 v97, 1, v12
  v_mul_u32_u24 v97, 4160, v97
  v_sub_u32 v97, s77, v97
  v_lshrrev_b32 v98, 1, v12
  v_lshlrev_b32 v98, 2, v98
  v_sub_u32 v97, v97, v98
  v_lshl_add_u32 v97, v11, 4, v97
  v_lshrrev_b32 v100, 2, v1
  v_mul_u32_u24 v100, 80, v100
  v_and_b32 v101, 3, v1
  v_lshl_add_u32 v100, v101, 4, v100
  s_add_u32 s77, s62, 640
  v_add_u32 v100, s77, v100
  v_min_u32 v101, 39, v1
  v_lshl_add_u32 v101, v101, 4, s62
  s_waitcnt lgkmcnt(0)
  v_mov_b32 v40, 2
  ds_write_b32 v4, v40
  s_mov_b32 s85, 0x40000
HPS3:
  ds_read_b32 v40, v5
  s_waitcnt lgkmcnt(0)
  v_readfirstlane_b32 s3, v40
  s_cmp_ge_u32 s3, 2
  s_cbranch_scc1 HPS3D
  s_sleep 1
  s_sub_u32 s85, s85, 1
  s_cbranch_scc0 HPS3
HPS3D:
  s_waitcnt vmcnt(0)
  ds_write_b128 v101, v[36:39]
  ds_write_b128 v100, a[64:67] offset:0
  ds_write_b128 v100, a[68:71] offset:1280
  ds_write_b128 v100, a[72:75] offset:2560
  ds_write_b128 v100, a[76:79] offset:3840
  s_setprio 1
  ds_read_b128 a[0:3], v96 offset:240
  ds_read_b128 a[4:7], v96 offset:272
  ds_read_b128 a[8:11], v96 offset:2800
  ds_read_b128 a[12:15], v96 offset:2832
  v_subrev_u32 v98, 0, v97
  ds_read2_b32 a[32:33], v98 offset0:128 offset1:129
  ds_read2_b32 a[34:35], v98 offset0:130 offset1:131
  ds_read2_b32 a[36:37], v98 offset0:136 offset1:137
  ds_read2_b32 a[38:39], v98 offset0:138 offset1:139
  ds_read2_b32 a[40:41], v98 offset0:0 offset1:1
  ds_read2_b32 a[42:43], v98 offset0:2 offset1:3
  ds_read2_b32 a[44:45], v98 offset0:8 offset1:9
  ds_read2_b32 a[46:47], v98 offset0:10 offset1:11
  v_subrev_u32 v99, 1024, v97
  ds_read2_b32 a[48:49], v99 offset0:128 offset1:129
  ds_read2_b32 a[50:51], v99 offset0:130 offset1:131
  ds_read2_b32 a[52:53], v99 offset0:136 offset1:137
  ds_read2_b32 a[54:55], v99 offset0:138 offset1:139
  s_waitcnt lgkmcnt(8)
  v_mfma_f32_32x32x16_bf16 v[16:31], a[0:3], a[32:35], 0
  v_mfma_f32_32x32x16_bf16 v[32:47], a[8:11], a[32:35], 0
  v_mfma_f32_32x32x16_bf16 v[16:31], a[4:7], a[36:39], v[16:31]
  v_mfma_f32_32x32x16_bf16 v[32:47], a[12:15], a[36:39], v[32:47]
  ds_read2_b32 a[56:57], v99 offset0:0 offset1:1
  ds_read2_b32 a[58:59], v99 offset0:2 offset1:3
  ds_read2_b32 a[60:61], v99 offset0:8 offset1:9
  ds_read2_b32 a[62:63], v99 offset0:10 offset1:11
  s_waitcnt lgkmcnt(8)
  v_mfma_f32_32x32x16_bf16 v[56:71], a[0:3], a[40:43], 0
  v_mfma_f32_32x32x16_bf16 v[72:87], a[8:11], a[40:43], 0
  v_mfma_f32_32x32x16_bf16 v[56:71], a[4:7], a[44:47], v[56:71]
  v_mfma_f32_32x32x16_bf16 v[72:87], a[12:15], a[44:47], v[72:87]
  v_subrev_u32 v98, 2048, v97
  ds_read2_b32 a[32:33], v98 offset0:128 offset1:129
  ds_read2_b32 a[34:35], v98 offset0:130 offset1:131
  ds_read2_b32 a[36:37], v98 offset0:136 offset1:137
  ds_read2_b32 a[38:39], v98 offset0:138 offset1:139
  s_waitcnt lgkmcnt(8)
  v_mfma_f32_32x32x16_bf16 v[24:39], a[0:3], a[48:51], v[24:39]
  v_mfma_f32_32x32x16_bf16 v[40:55], a[8:11], a[48:51], v[40:55]
  v_mfma_f32_32x32x16_bf16 v[24:39], a[4:7], a[52:55], v[24:39]
  v_mfma_f32_32x32x16_bf16 v[40:55], a[12:15], a[52:55], v[40:55]
  ds_read2_b32 a[40:41], v98 offset0:0 offset1:1
  ds_read2_b32 a[42:43], v98 offset0:2 offset1:3
  ds_read2_b32 a[44:45], v98 offset0:8 offset1:9
  ds_read2_b32 a[46:47], v98 offset0:10 offset1:11
  ds_read_b128 a[16:19], v96 offset:160
  ds_read_b128 a[20:23], v96 offset:192
  s_waitcnt lgkmcnt(10)
  v_mfma_f32_32x32x16_bf16 v[64:79], a[0:3], a[56:59], v[64:79]
  v_mfma_f32_32x32x16_bf16 v[80:95], a[8:11], a[56:59], v[80:95]
  v_mfma_f32_32x32x16_bf16 v[64:79], a[4:7], a[60:63], v[64:79]
  v_mfma_f32_32x32x16_bf16 v[80:95], a[12:15], a[60:63], v[80:95]
  v_subrev_u32 v99, 3072, v97
  ds_read2_b32 a[48:49], v99 offset0:128 offset1:129
  ds_read2_b32 a[50:51], v99 offset0:130 offset1:131
  ds_read2_b32 a[52:53], v99 offset0:136 offset1:137
  ds_read2_b32 a[54:55], v99 offset0:138 offset1:139
  ds_read_b128 a[24:27], v96 offset:2720
  ds_read_b128 a[28:31], v96 offset:2752
  s_waitcnt lgkmcnt(12)
  v_mfma_f32_32x32x16_bf16 v[32:47], a[0:3], a[32:35], v[32:47]
  v_mfma_f32_32x32x16_bf16 v[32:47], a[4:7], a[36:39], v[32:47]
  ds_read2_b32 a[56:57], v99 offset0:0 offset1:1
  ds_read2_b32 a[58:59], v99 offset0:2 offset1:3
  ds_read2_b32 a[60:61], v99 offset0:8 offset1:9
  ds_read2_b32 a[62:63], v99 offset0:10 offset1:11
  s_waitcnt lgkmcnt(12)
  v_mfma_f32_32x32x16_bf16 v[72:87], a[0:3], a[40:43], v[72:87]
  v_mfma_f32_32x32x16_bf16 v[72:87], a[4:7], a[44:47], v[72:87]
  v_subrev_u32 v98, 64, v97
  ds_read2_b32 a[32:33], v98 offset0:128 offset1:129
  ds_read2_b32 a[34:35], v98 offset0:130 offset1:131
  ds_read2_b32 a[36:37], v98 offset0:136 offset1:137
  ds_read2_b32 a[38:39], v98 offset0:138 offset1:139
  s_waitcnt lgkmcnt(10)
  v_mfma_f32_32x32x16_bf16 v[40:55], a[0:3], a[48:51], v[40:55]
  v_mfma_f32_32x32x16_bf16 v[40:55], a[4:7], a[52:55], v[40:55]
  ds_read2_b32 a[40:41], v98 offset0:0 offset1:1
  ds_read2_b32 a[42:43], v98 offset0:2 offset1:3
  ds_read2_b32 a[44:45], v98 offset0:8 offset1:9
  ds_read2_b32 a[46:47], v98 offset0:10 offset1:11
  s_waitcnt lgkmcnt(8)
  v_mfma_f32_32x32x16_bf16 v[80:95], a[0:3], a[56:59], v[80:95]
  v_mfma_f32_32x32x16_bf16 v[80:95], a[4:7], a[60:63], v[80:95]
  v_subrev_u32 v99, 1088, v97
  ds_read2_b32 a[48:49], v99 offset0:128 offset1:129
  ds_read2_b32 a[50:51], v99 offset0:130 offset1:131
  ds_read2_b32 a[52:53], v99 offset0:136 offset1:137
  ds_read2_b32 a[54:55], v99 offset0:138 offset1:139
  s_waitcnt lgkmcnt(8)
  v_mfma_f32_32x32x16_bf16 v[16:31], a[16:19], a[32:35], v[16:31]
  v_mfma_f32_32x32x16_bf16 v[32:47], a[24:27], a[32:35], v[32:47]
  v_mfma_f32_32x32x16_bf16 v[16:31], a[20:23], a[36:39], v[16:31]
  v_mfma_f32_32x32x16_bf16 v[32:47], a[28:31], a[36:39], v[32:47]
  ds_read2_b32 a[56:57], v99 offset0:0 offset1:1
  ds_read2_b32 a[58:59], v99 offset0:2 offset1:3
  ds_read2_b32 a[60:61], v99 offset0:8 offset1:9
  ds_read2_b32 a[62:63], v99 offset0:10 offset1:11
  s_waitcnt lgkmcnt(8)
  v_mfma_f32_32x32x16_bf16 v[56:71], a[16:19], a[40:43], v[56:71]
  v_mfma_f32_32x32x16_bf16 v[72:87], a[24:27], a[40:43], v[72:87]
  v_mfma_f32_32x32x16_bf16 v[56:71], a[20:23], a[44:47], v[56:71]
  v_mfma_f32_32x32x16_bf16 v[72:87], a[28:31], a[44:47], v[72:87]
  v_subrev_u32 v98, 2112, v97
  ds_read2_b32 a[32:33], v98 offset0:128 offset1:129
  ds_read2_b32 a[34:35], v98 offset0:130 offset1:131
  ds_read2_b32 a[36:37], v98 offset0:136 offset1:137
  ds_read2_b32 a[38:39], v98 offset0:138 offset1:139
  s_waitcnt lgkmcnt(8)
  v_mfma_f32_32x32x16_bf16 v[24:39], a[16:19], a[48:51], v[24:39]
  v_mfma_f32_32x32x16_bf16 v[40:55], a[24:27], a[48:51], v[40:55]
  v_mfma_f32_32x32x16_bf16 v[24:39], a[20:23], a[52:55], v[24:39]
  v_mfma_f32_32x32x16_bf16 v[40:55], a[28:31], a[52:55], v[40:55]
  ds_read2_b32 a[40:41], v98 offset0:0 offset1:1
  ds_read2_b32 a[42:43], v98 offset0:2 offset1:3
  ds_read2_b32 a[44:45], v98 offset0:8 offset1:9
  ds_read2_b32 a[46:47], v98 offset0:10 offset1:11
  ds_read_b128 a[0:3], v96 offset:80
  ds_read_b128 a[4:7], v96 offset:112
  s_waitcnt lgkmcnt(10)
  v_mfma_f32_32x32x16_bf16 v[64:79], a[16:19], a[56:59], v[64:79]
  v_mfma_f32_32x32x16_bf16 v[80:95], a[24:27], a[56:59], v[80:95]
  v_mfma_f32_32x32x16_bf16 v[64:79], a[20:23], a[60:63], v[64:79]
  v_mfma_f32_32x32x16_bf16 v[80:95], a[28:31], a[60:63], v[80:95]
  v_subrev_u32 v99, 3136, v97
  ds_read2_b32 a[48:49], v99 offset0:128 offset1:129
  ds_read2_b32 a[50:51], v99 offset0:130 offset1:131
  ds_read2_b32 a[52:53], v99 offset0:136 offset1:137
  ds_read2_b32 a[54:55], v99 offset0:138 offset1:139
  ds_read_b128 a[8:11], v96 offset:2640
  ds_read_b128 a[12:15], v96 offset:2672
  s_waitcnt lgkmcnt(12)
  v_mfma_f32_32x32x16_bf16 v[32:47], a[16:19], a[32:35], v[32:47]
  v_mfma_f32_32x32x16_bf16 v[32:47], a[20:23], a[36:39], v[32:47]
  ds_read2_b32 a[56:57], v99 offset0:0 offset1:1
  ds_read2_b32 a[58:59], v99 offset0:2 offset1:3
  ds_read2_b32 a[60:61], v99 offset0:8 offset1:9
  ds_read2_b32 a[62:63], v99 offset0:10 offset1:11
  s_waitcnt lgkmcnt(12)
  v_mfma_f32_32x32x16_bf16 v[72:87], a[16:19], a[40:43], v[72:87]
  v_mfma_f32_32x32x16_bf16 v[72:87], a[20:23], a[44:47], v[72:87]
  v_subrev_u32 v98, 128, v97
  ds_read2_b32 a[32:33], v98 offset0:128 offset1:129
  ds_read2_b32 a[34:35], v98 offset0:130 offset1:131
  ds_read2_b32 a[36:37], v98 offset0:136 offset1:137
  ds_read2_b32 a[38:39], v98 offset0:138 offset1:139
  s_waitcnt lgkmcnt(10)
  v_mfma_f32_32x32x16_bf16 v[40:55], a[16:19], a[48:51], v[40:55]
  v_mfma_f32_32x32x16_bf16 v[40:55], a[20:23], a[52:55], v[40:55]
  ds_read2_b32 a[40:41], v98 offset0:0 offset1:1
  ds_read2_b32 a[42:43], v98 offset0:2 offset1:3
  ds_read2_b32 a[44:45], v98 offset0:8 offset1:9
  ds_read2_b32 a[46:47], v98 offset0:10 offset1:11
  s_waitcnt lgkmcnt(8)
  v_mfma_f32_32x32x16_bf16 v[80:95], a[16:19], a[56:59], v[80:95]
  v_mfma_f32_32x32x16_bf16 v[80:95], a[20:23], a[60:63], v[80:95]
  v_subrev_u32 v99, 1152, v97
  ds_read2_b32 a[48:49], v99 offset0:128 offset1:129
  ds_read2_b32 a[50:51], v99 offset0:130 offset1:131
  ds_read2_b32 a[52:53], v99 offset0:136 offset1:137
  ds_read2_b32 a[54:55], v99 offset0:138 offset1:139
  s_waitcnt lgkmcnt(8)
  v_mfma_f32_32x32x16_bf16 v[16:31], a[0:3], a[32:35], v[16:31]
  v_mfma_f32_32x32x16_bf16 v[32:47], a[8:11], a[32:35], v[32:47]
  v_mfma_f32_32x32x16_bf16 v[16:31], a[4:7], a[36:39], v[16:31]
  v_mfma_f32_32x32x16_bf16 v[32:47], a[12:15], a[36:39], v[32:47]
  ds_read2_b32 a[56:57], v99 offset0:0 offset1:1
  ds_read2_b32 a[58:59], v99 offset0:2 offset1:3
  ds_read2_b32 a[60:61], v99 offset0:8 offset1:9
  ds_read2_b32 a[62:63], v99 offset0:10 offset1:11
  s_waitcnt lgkmcnt(8)
  v_mfma_f32_32x32x16_bf16 v[56:71], a[0:3], a[40:43], v[56:71]
  v_mfma_f32_32x32x16_bf16 v[72:87], a[8:11], a[40:43], v[72:87]
  v_mfma_f32_32x32x16_bf16 v[56:71], a[4:7], a[44:47], v[56:71]
  v_mfma_f32_32x32x16_bf16 v[72:87], a[12:15], a[44:47], v[72:87]
  v_subrev_u32 v98, 2176, v97
  ds_read2_b32 a[32:33], v98 offset0:128 offset1:129
  ds_read2_b32 a[34:35], v98 offset0:130 offset1:131
  ds_read2_b32 a[36:37], v98 offset0:136 offset1:137
  ds_read2_b32 a[38:39], v98 offset0:138 offset1:139
  s_waitcnt lgkmcnt(8)
  v_mfma_f32_32x32x16_bf16 v[24:39], a[0:3], a[48:51], v[24:39]
  v_mfma_f32_32x32x16_bf16 v[40:55], a[8:11], a[48:51], v[40:55]
  v_mfma_f32_32x32x16_bf16 v[24:39], a[4:7], a[52:55], v[24:39]
  v_mfma_f32_32x32x16_bf16 v[40:55], a[12:15], a[52:55], v[40:55]
  ds_read2_b32 a[40:41], v98 offset0:0 offset1:1
  ds_read2_b32 a[42:43], v98 offset0:2 offset1:3
  ds_read2_b32 a[44:45], v98 offset0:8 offset1:9
  ds_read2_b32 a[46:47], v98 offset0:10 offset1:11
  ds_read_b128 a[16:19], v96 offset:0
  ds_read_b128 a[20:23], v96 offset:32
  s_waitcnt lgkmcnt(10)
  v_mfma_f32_32x32x16_bf16 v[64:79], a[0:3], a[56:59], v[64:79]
  v_mfma_f32_32x32x16_bf16 v[80:95], a[8:11], a[56:59], v[80:95]
  v_mfma_f32_32x32x16_bf16 v[64:79], a[4:7], a[60:63], v[64:79]
  v_mfma_f32_32x32x16_bf16 v[80:95], a[12:15], a[60:63], v[80:95]
  v_subrev_u32 v99, 3200, v97
  ds_read2_b32 a[48:49], v99 offset0:128 offset1:129
  ds_read2_b32 a[50:51], v99 offset0:130 offset1:131
  ds_read2_b32 a[52:53], v99 offset0:136 offset1:137
  ds_read2_b32 a[54:55], v99 offset0:138 offset1:139
  ds_read_b128 a[24:27], v96 offset:2560
  ds_read_b128 a[28:31], v96 offset:2592
  s_waitcnt lgkmcnt(12)
  v_mfma_f32_32x32x16_bf16 v[32:47], a[0:3], a[32:35], v[32:47]
  v_mfma_f32_32x32x16_bf16 v[32:47], a[4:7], a[36:39], v[32:47]
  ds_read2_b32 a[56:57], v99 offset0:0 offset1:1
  ds_read2_b32 a[58:59], v99 offset0:2 offset1:3
  ds_read2_b32 a[60:61], v99 offset0:8 offset1:9
  ds_read2_b32 a[62:63], v99 offset0:10 offset1:11
  s_waitcnt lgkmcnt(12)
  v_mfma_f32_32x32x16_bf16 v[72:87], a[0:3], a[40:43], v[72:87]
  v_mfma_f32_32x32x16_bf16 v[72:87], a[4:7], a[44:47], v[72:87]
  v_subrev_u32 v98, 192, v97
  ds_read2_b32 a[32:33], v98 offset0:128 offset1:129
  ds_read2_b32 a[34:35], v98 offset0:130 offset1:131
  ds_read2_b32 a[36:37], v98 offset0:136 offset1:137
  ds_read2_b32 a[38:39], v98 offset0:138 offset1:139
  s_waitcnt lgkmcnt(10)
  v_mfma_f32_32x32x16_bf16 v[40:55], a[0:3], a[48:51], v[40:55]
  v_mfma_f32_32x32x16_bf16 v[40:55], a[4:7], a[52:55], v[40:55]
  ds_read2_b32 a[40:41], v98 offset0:0 offset1:1
  ds_read2_b32 a[42:43], v98 offset0:2 offset1:3
  ds_read2_b32 a[44:45], v98 offset0:8 offset1:9
  ds_read2_b32 a[46:47], v98 offset0:10 offset1:11
  s_waitcnt lgkmcnt(8)
  v_mfma_f32_32x32x16_bf16 v[80:95], a[0:3], a[56:59], v[80:95]
  v_mfma_f32_32x32x16_bf16 v[80:95], a[4:7], a[60:63], v[80:95]
  v_subrev_u32 v99, 1216, v97
  ds_read2_b32 a[48:49], v99 offset0:128 offset1:129
  ds_read2_b32 a[50:51], v99 offset0:130 offset1:131
  ds_read2_b32 a[52:53], v99 offset0:136 offset1:137
  ds_read2_b32 a[54:55], v99 offset0:138 offset1:139
  s_waitcnt lgkmcnt(8)
  v_mfma_f32_32x32x16_bf16 v[16:31], a[16:19], a[32:35], v[16:31]
  v_mfma_f32_32x32x16_bf16 v[32:47], a[24:27], a[32:35], v[32:47]
  v_mfma_f32_32x32x16_bf16 v[16:31], a[20:23], a[36:39], v[16:31]
  v_mfma_f32_32x32x16_bf16 v[32:47], a[28:31], a[36:39], v[32:47]
  ds_read2_b32 a[56:57], v99 offset0:0 offset1:1
  ds_read2_b32 a[58:59], v99 offset0:2 offset1:3
  ds_read2_b32 a[60:61], v99 offset0:8 offset1:9
  ds_read2_b32 a[62:63], v99 offset0:10 offset1:11
  s_waitcnt lgkmcnt(8)
  v_mfma_f32_32x32x16_bf16 v[56:71], a[16:19], a[40:43], v[56:71]
  v_mfma_f32_32x32x16_bf16 v[72:87], a[24:27], a[40:43], v[72:87]
  v_mfma_f32_32x32x16_bf16 v[56:71], a[20:23], a[44:47], v[56:71]
  v_mfma_f32_32x32x16_bf16 v[72:87], a[28:31], a[44:47], v[72:87]
  v_subrev_u32 v98, 2240, v97
  ds_read2_b32 a[32:33], v98 offset0:128 offset1:129
  ds_read2_b32 a[34:35], v98 offset0:130 offset1:131
  ds_read2_b32 a[36:37], v98 offset0:136 offset1:137
  ds_read2_b32 a[38:39], v98 offset0:138 offset1:139
  s_waitcnt lgkmcnt(8)
  v_mfma_f32_32x32x16_bf16 v[24:39], a[16:19], a[48:51], v[24:39]
  v_mfma_f32_32x32x16_bf16 v[40:55], a[24:27], a[48:51], v[40:55]
  v_mfma_f32_32x32x16_bf16 v[24:39], a[20:23], a[52:55], v[24:39]
  v_mfma_f32_32x32x16_bf16 v[40:55], a[28:31], a[52:55], v[40:55]
  ds_read2_b32 a[40:41], v98 offset0:0 offset1:1
  ds_read2_b32 a[42:43], v98 offset0:2 offset1:3
  ds_read2_b32 a[44:45], v98 offset0:8 offset1:9
  ds_read2_b32 a[46:47], v98 offset0:10 offset1:11
  s_waitcnt lgkmcnt(8)
  v_mfma_f32_32x32x16_bf16 v[64:79], a[16:19], a[56:59], v[64:79]
  v_mfma_f32_32x32x16_bf16 v[80:95], a[24:27], a[56:59], v[80:95]
  v_mfma_f32_32x32x16_bf16 v[64:79], a[20:23], a[60:63], v[64:79]
  v_mfma_f32_32x32x16_bf16 v[80:95], a[28:31], a[60:63], v[80:95]
  v_subrev_u32 v99, 3264, v97
  ds_read2_b32 a[48:49], v99 offset0:128 offset1:129
  ds_read2_b32 a[50:51], v99 offset0:130 offset1:131
  ds_read2_b32 a[52:53], v99 offset0:136 offset1:137
  ds_read2_b32 a[54:55], v99 offset0:138 offset1:139
  s_waitcnt lgkmcnt(8)
  v_mfma_f32_32x32x16_bf16 v[32:47], a[16:19], a[32:35], v[32:47]
  v_mfma_f32_32x32x16_bf16 v[32:47], a[20:23], a[36:39], v[32:47]
  ds_read2_b32 a[56:57], v99 offset0:0 offset1:1
  ds_read2_b32 a[58:59], v99 offset0:2 offset1:3
  ds_read2_b32 a[60:61], v99 offset0:8 offset1:9
  ds_read2_b32 a[62:63], v99 offset0:10 offset1:11
  s_waitcnt lgkmcnt(8)
  v_mfma_f32_32x32x16_bf16 v[72:87], a[16:19], a[40:43], v[72:87]
  v_mfma_f32_32x32x16_bf16 v[72:87], a[20:23], a[44:47], v[72:87]
  s_waitcnt lgkmcnt(4)
  s_nop 1
  v_mfma_f32_32x32x16_bf16 v[40:55], a[16:19], a[48:51], v[40:55]
  v_mfma_f32_32x32x16_bf16 v[40:55], a[20:23], a[52:55], v[40:55]
  s_waitcnt lgkmcnt(0)
  s_nop 3
  v_mfma_f32_32x32x16_bf16 v[80:95], a[16:19], a[56:59], v[80:95]
  v_mfma_f32_32x32x16_bf16 v[80:95], a[20:23], a[60:63], v[80:95]
  s_setprio 3
  v_lshl_add_u32 v96, v11, 7, v12
  v_lshl_add_u32 v96, v96, 2, s62
  v_add_u32 v97, 128, v96
  s_and_b32 s3, s61, 1
  s_lshl_b32 s5, s3, 12
  s_add_u32 s5, s5, s76
  v_lshl_add_u32 v98, v1, 5, s5
  s_lshl_b32 s3, s3, 11
  s_add_u32 s74, s74, s3
  s_add_u32 s74, s74, 10485760
  v_add_f32 v20, v20, v56
  v_add_f32 v21, v21, v57
  v_add_f32 v22, v22, v58
  v_add_f32 v23, v23, v59
  v_add_f32 v24, v24, v60
  v_add_f32 v25, v25, v61
  v_add_f32 v26, v26, v62
  v_add_f32 v27, v27, v63
  v_add_f32 v28, v28, v64
  v_add_f32 v29, v29, v65
  v_add_f32 v30, v30, v66
  v_add_f32 v31, v31, v67
  v_add_f32 v32, v32, v68
  v_add_f32 v33, v33, v69
  v_add_f32 v34, v34, v70
  v_add_f32 v35, v35, v71
  v_add_f32 v36, v36, v72
  v_add_f32 v37, v37, v73
  v_add_f32 v38, v38, v74
  v_add_f32 v39, v39, v75
  v_add_f32 v40, v40, v76
  v_add_f32 v41, v41, v77
  v_add_f32 v42, v42, v78
  v_add_f32 v43, v43, v79
  v_add_f32 v44, v44, v80
  v_add_f32 v45, v45, v81
  v_add_f32 v46, v46, v82
  v_add_f32 v47, v47, v83
  ds_write2st64_b32 v96, v16, v18 offset0:0 offset1:1
  ds_write2st64_b32 v97, v17, v19 offset0:0 offset1:1
  ds_write2st64_b32 v96, v20, v22 offset0:4 offset1:5
  ds_write2st64_b32 v97, v21, v23 offset0:4 offset1:5
  ds_write2st64_b32 v96, v24, v26 offset0:8 offset1:9
  ds_write2st64_b32 v97, v25, v27 offset0:8 offset1:9
  ds_write2st64_b32 v96, v28, v30 offset0:12 offset1:13
  ds_write2st64_b32 v97, v29, v31 offset0:12 offset1:13
  ds_write2st64_b32 v96, v32, v34 offset0:16 offset1:17
  ds_write2st64_b32 v97, v33, v35 offset0:16 offset1:17
  ds_write2st64_b32 v96, v36, v38 offset0:20 offset1:21
  ds_write2st64_b32 v97, v37, v39 offset0:20 offset1:21
  ds_write2st64_b32 v96, v40, v42 offset0:24 offset1:25
  ds_write2st64_b32 v97, v41, v43 offset0:24 offset1:25
  ds_write2st64_b32 v96, v44, v46 offset0:28 offset1:29
  ds_write2st64_b32 v97, v45, v47 offset0:28 offset1:29
  s_waitcnt lgkmcnt(0)
  v_mov_b32 v100, 3
  ds_write_b32 v4, v100
  s_mov_b32 s85, 0x40000
HPS4:
  ds_read_b32 v100, v5
  s_waitcnt lgkmcnt(0)
  v_readfirstlane_b32 s3, v100
  s_cmp_ge_u32 s3, 3
  s_cbranch_scc1 HPS4D
  s_sleep 1
  s_sub_u32 s85, s85, 1
  s_cbranch_scc0 HPS4
HPS4D:
  ds_read_b128 v[48:51], v98 offset:0
  ds_read_b128 v[52:55], v98 offset:16
  ds_read_b128 v[56:59], v98 offset:8448
  ds_read_b128 v[60:63], v98 offset:8464
  ds_read_b128 v[64:67], v98 offset:2048
  ds_read_b128 v[68:71], v98 offset:2064
  ds_read_b128 v[72:75], v98 offset:10496
  ds_read_b128 v[76:79], v98 offset:10512
  v_lshlrev_b32 v9, 2, v13
  v_and_b32 v104, 7, v1
  v_lshrrev_b32 v105, 3, v1
  v_lshlrev_b32 v100, 12, v105
  v_lshl_add_u32 v100, v104, 4, v100
  s_add_u32 s68, s68, 10485760
  s_add_u32 s67, s68, 32768
  s_and_b32 s3, s61, 1
  s_mul_i32 s3, s3, 2304
  s_add_u32 s3, s3, s79
  v_mul_u32_u24 v101, 144, v105
  v_lshl_add_u32 v101, v104, 4, v101
  v_add_u32 v101, s3, v101
  v_and_b32 v104, 1, v15
  v_lshrrev_b32 v105, 1, v15
  v_lshl_add_u32 v102, v104, 3, v14
  v_mul_u32_u24 v102, 144, v102
  v_lshl_add_u32 v102, v105, 5, v102
  v_and_b32 v106, 3, v1
  v_lshl_add_u32 v102, v106, 3, v102
  v_add_u32 v102, s3, v102
  v_lshl_add_u32 v103, v105, 4, v13
  v_mul_u32_u24 v103, 1792, v103
  v_lshl_add_u32 v103, v104, 4, v103
  s_mul_i32 s3, s34, 114688
  s_lshl_b32 s5, s61, 5
  s_add_u32 s3, s3, s5
  s_add_u32 s3, s3, s65
  s_add_u32 s3, s3, 896
  v_add_u32 v103, s3, v103
  s_mov_b32 s66, 57344
  s_waitcnt lgkmcnt(4)
  v_add_f32 v48, v48, v56
  v_add_f32 v49, v49, v57
  v_add_f32 v50, v50, v58
  v_add_f32 v51, v51, v59
  v_add_f32 v52, v52, v60
  v_add_f32 v53, v53, v61
  v_add_f32 v54, v54, v62
  v_add_f32 v55, v55, v63
  v_cvt_pk_bf16_f32 v80, v48, v49
  v_cvt_pk_bf16_f32 v81, v50, v51
  v_cvt_pk_bf16_f32 v82, v52, v53
  v_cvt_pk_bf16_f32 v83, v54, v55
  buffer_store_dwordx4 v[80:83], v2, s[24:27], s74 offen offset:0 sc1
  s_waitcnt lgkmcnt(0)
  v_add_f32 v64, v64, v72
  v_add_f32 v65, v65, v73
  v_add_f32 v66, v66, v74
  v_add_f32 v67, v67, v75
  v_add_f32 v68, v68, v76
  v_add_f32 v69, v69, v77
  v_add_f32 v70, v70, v78
  v_add_f32 v71, v71, v79
  v_cvt_pk_bf16_f32 v84, v64, v65
  v_cvt_pk_bf16_f32 v85, v66, v67
  v_cvt_pk_bf16_f32 v86, v68, v69
  v_cvt_pk_bf16_f32 v87, v70, v71
  buffer_store_dwordx4 v[84:87], v2, s[24:27], s74 offen offset:1024 sc1
  s_waitcnt vmcnt(0)
  v_mov_b32 v33, s56
  s_mov_b64 exec, 0xffff
  buffer_store_dword v33, v127, s[24:27], s70 offen sc1
  s_mov_b64 exec, -1
  ds_read_b128 v[104:107], v3
  s_waitcnt lgkmcnt(0)
  v_min3_u32 v104, v104, v105, v106
  v_min_u32 v104, v104, v107
  s_nop 0
  v_readfirstlane_b32 s3, v104
  s_cmp_ge_u32 s3, 5
  s_cbranch_scc0 HMC5
HMC5D:
  s_add_u32 m0, s73, 0
  s_mov_b32 s3, 0
  s_mov_b64 exec, s[80:81]
  buffer_load_dwordx4 v8, s[16:19], s3 offen lds
  s_mov_b64 exec, -1
  s_add_u32 m0, s73, 896
  s_mov_b32 s3, 3584
  s_mov_b64 exec, s[80:81]
  buffer_load_dwordx4 v8, s[16:19], s3 offen lds
  s_mov_b64 exec, -1
  s_add_u32 m0, s73, 1792
  s_mov_b32 s3, 7168
  s_mov_b64 exec, s[80:81]
  buffer_load_dwordx4 v8, s[16:19], s3 offen lds
  s_mov_b64 exec, -1
  s_waitcnt vmcnt(2)
  s_add_u32 m0, s73, 2688
  s_mov_b32 s3, 10752
  s_mov_b64 exec, s[80:81]
  buffer_load_dwordx4 v8, s[16:19], s3 offen lds
  s_mov_b64 exec, -1
  s_waitcnt vmcnt(2)
  s_add_u32 m0, s73, 3584
  s_mov_b32 s3, 14336
  s_mov_b64 exec, s[80:81]
  buffer_load_dwordx4 v8, s[16:19], s3 offen lds
  s_mov_b64 exec, -1
  s_waitcnt vmcnt(2)
  s_add_u32 m0, s73, 4480
  s_mov_b32 s3, 17920
  s_mov_b64 exec, s[80:81]
  buffer_load_dwordx4 v8, s[16:19], s3 offen lds
  s_mov_b64 exec, -1
  s_waitcnt vmcnt(2)
  s_add_u32 m0, s73, 5376
  s_mov_b32 s3, 21504
  s_mov_b64 exec, s[80:81]
  buffer_load_dwordx4 v8, s[16:19], s3 offen lds
  s_mov_b64 exec, -1
  s_waitcnt vmcnt(2)
  s_add_u32 m0, s73, 6272
  s_mov_b32 s3, 25088
  s_mov_b64 exec, s[80:81]
  buffer_load_dwordx4 v8, s[16:19], s3 offen lds
  s_mov_b64 exec, -1
  s_waitcnt vmcnt(2)
  s_add_u32 m0, s73, 7168
  s_mov_b32 s3, 28672
  s_mov_b64 exec, s[80:81]
  buffer_load_dwordx4 v8, s[16:19], s3 offen lds
  s_mov_b64 exec, -1
  s_waitcnt vmcnt(2)
  s_add_u32 m0, s73, 8064
  s_mov_b32 s3, 32256
  s_mov_b64 exec, s[80:81]
  buffer_load_dwordx4 v8, s[16:19], s3 offen lds
  s_mov_b64 exec, -1
  s_waitcnt vmcnt(2)
  s_add_u32 m0, s73, 8960
  s_mov_b32 s3, 35840
  s_mov_b64 exec, s[80:81]
  buffer_load_dwordx4 v8, s[16:19], s3 offen lds
  s_mov_b64 exec, -1
  s_waitcnt vmcnt(2)
  s_add_u32 m0, s73, 9856
  s_mov_b32 s3, 39424
  s_mov_b64 exec, s[80:81]
  buffer_load_dwordx4 v8, s[16:19], s3 offen lds
  s_mov_b64 exec, -1
  s_waitcnt vmcnt(2)
  s_add_u32 m0, s73, 10752
  s_mov_b32 s3, 43008
  s_mov_b64 exec, s[80:81]
  buffer_load_dwordx4 v8, s[16:19], s3 offen lds
  s_mov_b64 exec, -1
  s_waitcnt vmcnt(2)
  s_add_u32 m0, s73, 11648
  s_mov_b32 s3, 46592
  s_mov_b64 exec, s[80:81]
  buffer_load_dwordx4 v8, s[16:19], s3 offen lds
  s_mov_b64 exec, -1
  s_waitcnt vmcnt(2)
  s_add_u32 m0, s73, 12544
  s_mov_b32 s3, 50176
  s_mov_b64 exec, s[80:81]
  buffer_load_dwordx4 v8, s[16:19], s3 offen lds
  s_mov_b64 exec, -1
  s_waitcnt vmcnt(2)
  s_add_u32 m0, s73, 13440
  s_mov_b32 s3, 53760
  s_mov_b64 exec, s[80:81]
  buffer_load_dwordx4 v8, s[16:19], s3 offen lds
  s_mov_b64 exec, -1
  s_waitcnt vmcnt(2)
  s_add_u32 m0, s73, 14336
  s_mov_b32 s3, 57344
  s_mov_b64 exec, s[80:81]
  buffer_load_dwordx4 v8, s[16:19], s3 offen lds
  s_mov_b64 exec, -1
  s_waitcnt vmcnt(2)
  s_add_u32 m0, s73, 15232
  s_mov_b32 s3, 60928
  s_mov_b64 exec, s[80:81]
  buffer_load_dwordx4 v8, s[16:19], s3 offen lds
  s_mov_b64 exec, -1
  s_waitcnt vmcnt(2)
  s_add_u32 m0, s73, 16128
  s_mov_b32 s3, 64512
  s_mov_b64 exec, s[80:81]
  buffer_load_dwordx4 v8, s[16:19], s3 offen lds
  s_mov_b64 exec, -1
  s_waitcnt vmcnt(2)
  s_add_u32 m0, s73, 17024
  s_mov_b32 s3, 68096
  s_mov_b64 exec, s[80:81]
  buffer_load_dwordx4 v8, s[16:19], s3 offen lds
  s_mov_b64 exec, -1
  s_waitcnt vmcnt(2)
  s_add_u32 m0, s73, 17920
  s_mov_b32 s3, 71680
  s_mov_b64 exec, s[80:81]
  buffer_load_dwordx4 v8, s[16:19], s3 offen lds
  s_mov_b64 exec, -1
  s_waitcnt vmcnt(2)
  s_add_u32 m0, s73, 18816
  s_mov_b32 s3, 75264
  s_mov_b64 exec, s[80:81]
  buffer_load_dwordx4 v8, s[16:19], s3 offen lds
  s_mov_b64 exec, -1
  s_waitcnt vmcnt(2)
  s_add_u32 m0, s73, 19712
  s_mov_b32 s3, 78848
  s_mov_b64 exec, s[80:81]
  buffer_load_dwordx4 v8, s[16:19], s3 offen lds
  s_mov_b64 exec, -1
  s_waitcnt vmcnt(2)
  s_add_u32 m0, s73, 20608
  s_mov_b32 s3, 82432
  s_mov_b64 exec, s[80:81]
  buffer_load_dwordx4 v8, s[16:19], s3 offen lds
  s_mov_b64 exec, -1
  s_waitcnt vmcnt(2)
  s_add_u32 m0, s73, 21504
  s_mov_b32 s3, 86016
  s_mov_b64 exec, s[80:81]
  buffer_load_dwordx4 v8, s[16:19], s3 offen lds
  s_mov_b64 exec, -1
  s_waitcnt vmcnt(2)
  s_add_u32 m0, s73, 22400
  s_mov_b32 s3, 89600
  s_mov_b64 exec, s[80:81]
  buffer_load_dwordx4 v8, s[16:19], s3 offen lds
  s_mov_b64 exec, -1
  s_waitcnt vmcnt(2)
  s_add_u32 m0, s73, 23296
  s_mov_b32 s3, 93184
  s_mov_b64 exec, s[80:81]
  buffer_load_dwordx4 v8, s[16:19], s3 offen lds
  s_mov_b64 exec, -1
  s_waitcnt vmcnt(2)
  s_add_u32 m0, s73, 24192
  s_mov_b32 s3, 96768
  s_mov_b64 exec, s[80:81]
  buffer_load_dwordx4 v8, s[16:19], s3 offen lds
  s_mov_b64 exec, -1
  s_mov_b32 s85, 0x8000
HPOLL6:
  v_mov_b32 v33, 0
  s_mov_b64 exec, 0xffff
  buffer_atomic_or v33, v9, s[24:27], s72 offen sc0 sc1
  s_mov_b64 exec, -1
HPOLL6C:
  s_waitcnt vmcnt(0)
  v_cmp_ne_u32 vcc, s56, v33
  s_and_b64 vcc, vcc, 0xffff
  s_cbranch_scc0 HPOLL6D
  s_sleep 16
  s_sub_u32 s85, s85, 1
  s_cbranch_scc0 HPOLL6
HPOLL6D:
  buffer_load_dwordx4 v[16:19], v100, s[24:27], s68 offen sc1
  buffer_load_dwordx4 v[20:23], v100, s[24:27], s67 offen sc1
  s_waitcnt vmcnt(1)
  ds_write_b128 v101, v[16:19]
  s_waitcnt vmcnt(0)
  ds_write_b128 v101, v[20:23] offset:1152
  ds_read_b64_tr_b16 v[24:25], v102 offset:0
  ds_read_b64_tr_b16 v[26:27], v102 offset:576
  ds_read_b64_tr_b16 v[28:29], v102 offset:64
  ds_read_b64_tr_b16 v[30:31], v102 offset:640
  s_waitcnt lgkmcnt(2)
  buffer_store_dwordx4 v[24:27], v103, s[28:31], 0 offen sc1
  s_waitcnt lgkmcnt(0)
  buffer_store_dwordx4 v[28:31], v103, s[28:31], s66 offen sc1
HTAIL:
  s_lshr_b32 s55, s34, 2
  s_lshl_b32 s3, s33, 3
  s_add_u32 s55, s55, s3
  s_lshl_b32 s44, s55, 2
  s_add_u32 s44, s44, s54
  s_lshl_b32 s44, s44, 2
  s_add_u32 s44, s44, s61
  s_lshl_b32 s44, s44, 7
  s_add_u32 s44, s44, 6553600
  s_lshl_b32 s3, s55, 4
  s_lshl_b32 s37, s61, 2
  s_add_u32 s3, s3, s37
  s_lshl_b32 s3, s3, 11
  s_add_u32 s42, s3, 4194304
  s_add_u32 s43, s42, 4096
  v_and_b32 v126, 3, v1
  v_lshlrev_b32 v126, 2, v126
  s_add_u32 s3, s37, 161088
  v_mov_b32 v8, s3
  v_mov_b32 v14, 7
  s_mul_i32 s48, s61, 12288
  s_add_u32 s48, s48, 102400
  v_add_u32 v10, s48, v2
  s_mov_b32 m0, s48
  s_waitcnt vmcnt(0)
  s_setprio 3
  s_barrier
  s_barrier
  s_mov_b32 s85, 0x4000
  s_mov_b64 exec, 15
  v_mov_b32 v16, 0
  buffer_atomic_or v16, v126, s[24:27], s44 offen sc0 sc1
  s_sleep 6
OPL:
  v_mov_b32 v17, 0
  buffer_atomic_or v17, v126, s[24:27], s44 offen sc0 sc1
  ds_read_b32 v13, v8
  s_waitcnt vmcnt(1)
  v_cmp_ne_u32 vcc, s56, v16
  s_cbranch_vccz OPD
  v_mov_b32 v16, 0
  buffer_atomic_or v16, v126, s[24:27], s44 offen sc0 sc1
  ds_read_b32 v13, v8
  s_waitcnt vmcnt(1)
  v_cmp_ne_u32 vcc, s56, v17
  s_cbranch_vccz OPD
  s_sub_u32 s85, s85, 1
  s_cbranch_scc0 OPL
OPD:
  s_mov_b64 exec, -1
  s_waitcnt lgkmcnt(0)
  v_readfirstlane_b32 s3, v13
  s_cmp_ge_u32 s3, 6
  s_cbranch_scc1 HFD
  s_mov_b32 s85, 0x40000
HFR:
  ds_read_b32 v13, v8
  s_sub_u32 s85, s85, 1
  s_waitcnt lgkmcnt(0)
  s_cbranch_scc1 HFD
  v_readfirstlane_b32 s3, v13
  s_cmp_ge_u32 s3, 6
  s_cbranch_scc1 HFD
  s_sleep 1
  s_branch HFR
HFD:
  buffer_load_dwordx4 v2, s[24:27], s42 offen offset:0 sc1 lds
  buffer_load_dwordx4 v2, s[24:27], s42 offen offset:1024 sc1 lds
  buffer_load_dwordx4 v2, s[24:27], s42 offen offset:2048 sc1 lds
  buffer_load_dwordx4 v2, s[24:27], s42 offen offset:3072 sc1 lds
  s_add_u32 m0, s48, 4096
  s_nop 0
  buffer_load_dwordx4 v2, s[24:27], s43 offen offset:0 sc1 lds
  buffer_load_dwordx4 v2, s[24:27], s43 offen offset:1024 sc1 lds
  buffer_load_dwordx4 v2, s[24:27], s43 offen offset:2048 sc1 lds
  buffer_load_dwordx4 v2, s[24:27], s43 offen offset:3072 sc1 lds
  s_waitcnt vmcnt(0)
  s_mov_b64 exec, 1
  ds_write_b32 v8, v14
  s_mov_b64 exec, -1
  v_mov_b32 v14, 9
  s_mov_b32 s85, 0x1000
HVR:
  ds_read_b128 v[16:19], v10 offset:0
  ds_read_b128 v[20:23], v10 offset:1024
  ds_read_b128 v[24:27], v10 offset:2048
  ds_read_b128 v[28:31], v10 offset:3072
  ds_read_b128 v[32:35], v10 offset:4096
  ds_read_b128 v[36:39], v10 offset:5120
  ds_read_b128 v[40:43], v10 offset:6144
  ds_read_b128 v[44:47], v10 offset:7168
  s_waitcnt lgkmcnt(7)
  v_max3_u32 v12, v16, v17, v18
  v_mov_b32 v13, v19
  s_waitcnt lgkmcnt(6)
  v_max3_u32 v12, v20, v21, v12
  v_max3_u32 v13, v22, v23, v13
  s_waitcnt lgkmcnt(5)
  v_max3_u32 v12, v24, v25, v12
  v_max3_u32 v13, v26, v27, v13
  s_waitcnt lgkmcnt(4)
  v_max3_u32 v12, v28, v29, v12
  v_max3_u32 v13, v30, v31, v13
  s_waitcnt lgkmcnt(3)
  v_max3_u32 v12, v32, v33, v12
  v_max3_u32 v13, v34, v35, v13
  s_waitcnt lgkmcnt(2)
  v_max3_u32 v12, v36, v37, v12
  v_max3_u32 v13, v38, v39, v13
  s_waitcnt lgkmcnt(1)
  v_max3_u32 v12, v40, v41, v12
  v_max3_u32 v13, v42, v43, v13
  s_waitcnt lgkmcnt(0)
  v_max3_u32 v12, v44, v45, v12
  v_max3_u32 v13, v46, v47, v13
  v_max_u32 v12, v12, v13
  v_cmp_eq_u32 vcc, -1, v12
  s_cbranch_vccz HVD
  v_mov_b32 v14, 10
  s_sub_u32 s85, s85, 1
  s_cbranch_scc1 HVD
  s_sleep 2
  s_mov_b32 m0, s48
  s_nop 0
  buffer_load_dwordx4 v2, s[24:27], s42 offen offset:0 sc1 lds
  buffer_load_dwordx4 v2, s[24:27], s42 offen offset:1024 sc1 lds
  buffer_load_dwordx4 v2, s[24:27], s42 offen offset:2048 sc1 lds
  buffer_load_dwordx4 v2, s[24:27], s42 offen offset:3072 sc1 lds
  s_add_u32 m0, s48, 4096
  s_nop 0
  buffer_load_dwordx4 v2, s[24:27], s43 offen offset:0 sc1 lds
  buffer_load_dwordx4 v2, s[24:27], s43 offen offset:1024 sc1 lds
  buffer_load_dwordx4 v2, s[24:27], s43 offen offset:2048 sc1 lds
  buffer_load_dwordx4 v2, s[24:27], s43 offen offset:3072 sc1 lds
  s_waitcnt vmcnt(0)
  s_branch HVR
HVD:
  s_mov_b64 exec, 1
  ds_write_b32 v8, v14
  s_mov_b64 exec, -1
  s_waitcnt lgkmcnt(0)
  s_endpgm
HSKIP:
  ds_read_b128 v[104:107], v3
  s_waitcnt lgkmcnt(0)
  v_min3_u32 v104, v104, v105, v106
  v_min_u32 v104, v104, v107
  s_nop 0
  v_readfirstlane_b32 s3, v104
  s_cmp_ge_u32 s3, 5
  s_cbranch_scc0 HMC7
HMC7D:
  s_add_u32 m0, s73, 0
  s_mov_b32 s3, 0
  s_mov_b64 exec, s[80:81]
  buffer_load_dwordx4 v8, s[16:19], s3 offen lds
  s_mov_b64 exec, -1
  s_add_u32 m0, s73, 896
  s_mov_b32 s3, 3584
  s_mov_b64 exec, s[80:81]
  buffer_load_dwordx4 v8, s[16:19], s3 offen lds
  s_mov_b64 exec, -1
  s_add_u32 m0, s73, 1792
  s_mov_b32 s3, 7168
  s_mov_b64 exec, s[80:81]
  buffer_load_dwordx4 v8, s[16:19], s3 offen lds
  s_mov_b64 exec, -1
  s_waitcnt vmcnt(2)
  s_add_u32 m0, s73, 2688
  s_mov_b32 s3, 10752
  s_mov_b64 exec, s[80:81]
  buffer_load_dwordx4 v8, s[16:19], s3 offen lds
  s_mov_b64 exec, -1
  s_waitcnt vmcnt(2)
  s_add_u32 m0, s73, 3584
  s_mov_b32 s3, 14336
  s_mov_b64 exec, s[80:81]
  buffer_load_dwordx4 v8, s[16:19], s3 offen lds
  s_mov_b64 exec, -1
  s_waitcnt vmcnt(2)
  s_add_u32 m0, s73, 4480
  s_mov_b32 s3, 17920
  s_mov_b64 exec, s[80:81]
  buffer_load_dwordx4 v8, s[16:19], s3 offen lds
  s_mov_b64 exec, -1
  s_waitcnt vmcnt(2)
  s_add_u32 m0, s73, 5376
  s_mov_b32 s3, 21504
  s_mov_b64 exec, s[80:81]
  buffer_load_dwordx4 v8, s[16:19], s3 offen lds
  s_mov_b64 exec, -1
  s_waitcnt vmcnt(2)
  s_add_u32 m0, s73, 6272
  s_mov_b32 s3, 25088
  s_mov_b64 exec, s[80:81]
  buffer_load_dwordx4 v8, s[16:19], s3 offen lds
  s_mov_b64 exec, -1
  s_waitcnt vmcnt(2)
  s_add_u32 m0, s73, 7168
  s_mov_b32 s3, 28672
  s_mov_b64 exec, s[80:81]
  buffer_load_dwordx4 v8, s[16:19], s3 offen lds
  s_mov_b64 exec, -1
  s_waitcnt vmcnt(2)
  s_add_u32 m0, s73, 8064
  s_mov_b32 s3, 32256
  s_mov_b64 exec, s[80:81]
  buffer_load_dwordx4 v8, s[16:19], s3 offen lds
  s_mov_b64 exec, -1
  s_waitcnt vmcnt(2)
  s_add_u32 m0, s73, 8960
  s_mov_b32 s3, 35840
  s_mov_b64 exec, s[80:81]
  buffer_load_dwordx4 v8, s[16:19], s3 offen lds
  s_mov_b64 exec, -1
  s_waitcnt vmcnt(2)
  s_add_u32 m0, s73, 9856
  s_mov_b32 s3, 39424
  s_mov_b64 exec, s[80:81]
  buffer_load_dwordx4 v8, s[16:19], s3 offen lds
  s_mov_b64 exec, -1
  s_waitcnt vmcnt(2)
  s_add_u32 m0, s73, 10752
  s_mov_b32 s3, 43008
  s_mov_b64 exec, s[80:81]
  buffer_load_dwordx4 v8, s[16:19], s3 offen lds
  s_mov_b64 exec, -1
  s_waitcnt vmcnt(2)
  s_add_u32 m0, s73, 11648
  s_mov_b32 s3, 46592
  s_mov_b64 exec, s[80:81]
  buffer_load_dwordx4 v8, s[16:19], s3 offen lds
  s_mov_b64 exec, -1
  s_waitcnt vmcnt(2)
  s_add_u32 m0, s73, 12544
  s_mov_b32 s3, 50176
  s_mov_b64 exec, s[80:81]
  buffer_load_dwordx4 v8, s[16:19], s3 offen lds
  s_mov_b64 exec, -1
  s_waitcnt vmcnt(2)
  s_add_u32 m0, s73, 13440
  s_mov_b32 s3, 53760
  s_mov_b64 exec, s[80:81]
  buffer_load_dwordx4 v8, s[16:19], s3 offen lds
  s_mov_b64 exec, -1
  s_waitcnt vmcnt(2)
  s_add_u32 m0, s73, 14336
  s_mov_b32 s3, 57344
  s_mov_b64 exec, s[80:81]
  buffer_load_dwordx4 v8, s[16:19], s3 offen lds
  s_mov_b64 exec, -1
  s_waitcnt vmcnt(2)
  s_add_u32 m0, s73, 15232
  s_mov_b32 s3, 60928
  s_mov_b64 exec, s[80:81]
  buffer_load_dwordx4 v8, s[16:19], s3 offen lds
  s_mov_b64 exec, -1
  s_waitcnt vmcnt(2)
  s_add_u32 m0, s73, 16128
  s_mov_b32 s3, 64512
  s_mov_b64 exec, s[80:81]
  buffer_load_dwordx4 v8, s[16:19], s3 offen lds
  s_mov_b64 exec, -1
  s_waitcnt vmcnt(2)
  s_add_u32 m0, s73, 17024
  s_mov_b32 s3, 68096
  s_mov_b64 exec, s[80:81]
  buffer_load_dwordx4 v8, s[16:19], s3 offen lds
  s_mov_b64 exec, -1
  s_waitcnt vmcnt(2)
  s_add_u32 m0, s73, 17920
  s_mov_b32 s3, 71680
  s_mov_b64 exec, s[80:81]
  buffer_load_dwordx4 v8, s[16:19], s3 offen lds
  s_mov_b64 exec, -1
  s_waitcnt vmcnt(2)
  s_add_u32 m0, s73, 18816
  s_mov_b32 s3, 75264
  s_mov_b64 exec, s[80:81]
  buffer_load_dwordx4 v8, s[16:19], s3 offen lds
  s_mov_b64 exec, -1
  s_waitcnt vmcnt(2)
  s_add_u32 m0, s73, 19712
  s_mov_b32 s3, 78848
  s_mov_b64 exec, s[80:81]
  buffer_load_dwordx4 v8, s[16:19], s3 offen lds
  s_mov_b64 exec, -1
  s_waitcnt vmcnt(2)
  s_add_u32 m0, s73, 20608
  s_mov_b32 s3, 82432
  s_mov_b64 exec, s[80:81]
  buffer_load_dwordx4 v8, s[16:19], s3 offen lds
  s_mov_b64 exec, -1
  s_waitcnt vmcnt(2)
  s_add_u32 m0, s73, 21504
  s_mov_b32 s3, 86016
  s_mov_b64 exec, s[80:81]
  buffer_load_dwordx4 v8, s[16:19], s3 offen lds
  s_mov_b64 exec, -1
  s_waitcnt vmcnt(2)
  s_add_u32 m0, s73, 22400
  s_mov_b32 s3, 89600
  s_mov_b64 exec, s[80:81]
  buffer_load_dwordx4 v8, s[16:19], s3 offen lds
  s_mov_b64 exec, -1
  s_waitcnt vmcnt(2)
  s_add_u32 m0, s73, 23296
  s_mov_b32 s3, 93184
  s_mov_b64 exec, s[80:81]
  buffer_load_dwordx4 v8, s[16:19], s3 offen lds
  s_mov_b64 exec, -1
  s_waitcnt vmcnt(2)
  s_add_u32 m0, s73, 24192
  s_mov_b32 s3, 96768
  s_mov_b64 exec, s[80:81]
  buffer_load_dwordx4 v8, s[16:19], s3 offen lds
  s_mov_b64 exec, -1
  s_branch HTAIL
HMC5:
  s_mov_b32 s85, 0x40000
HMC5C:
  s_sleep 8
  ds_read_b128 v[104:107], v3
  s_sub_u32 s85, s85, 1
  s_waitcnt lgkmcnt(0)
  s_cbranch_scc1 HMC5D
  v_min3_u32 v104, v104, v105, v106
  v_min_u32 v104, v104, v107
  s_nop 0
  v_readfirstlane_b32 s3, v104
  s_cmp_ge_u32 s3, 5
  s_cbranch_scc0 HMC5C
  s_branch HMC5D
HMC7:
  s_mov_b32 s85, 0x40000
HMC7C:
  s_sleep 8
  ds_read_b128 v[104:107], v3
  s_sub_u32 s85, s85, 1
  s_waitcnt lgkmcnt(0)
  s_cbranch_scc1 HMC7D
  v_min3_u32 v104, v104, v105, v106
  v_min_u32 v104, v104, v107
  s_nop 0
  v_readfirstlane_b32 s3, v104
  s_cmp_ge_u32 s3, 5
  s_cbranch_scc0 HMC7C
  s_branch HMC7D
CODEEND:
.section .rodata,"a"
.p2align 6
.amdhsa_kernel concat_heads__mha_block__ssm_conv_s4__prompt_kernel
  .amdhsa_next_free_vgpr 256
  .amdhsa_next_free_sgpr 102
  .amdhsa_accum_offset 128
  .amdhsa_group_segment_fixed_size 0
  .amdhsa_kernarg_size 120
  .amdhsa_user_sgpr_count 2
  .amdhsa_user_sgpr_kernarg_segment_ptr 1
  .amdhsa_system_sgpr_workgroup_id_x 1
.end_amdhsa_kernel
```
